```python
import torch

def _softmax(x, axis=-1):
    return torch.softmax(x, dim=axis)
def _gelu(x):
    return torch.nn.functional.gelu(x, approximate="tanh")
def _silu(x):
    return torch.nn.functional.silu(x)
def _sigmoid(x):
    return torch.sigmoid(x)
def _layernorm(x, axis=-1, eps=1e-5):
    m = x.mean(dim=axis, keepdim=True)
    v = x.var(dim=axis, keepdim=True, unbiased=False)
    return (x - m) / torch.sqrt(v + eps)
def _scatter_add(tgt, idx, src, axis=0):
    return tgt.clone().index_add_(axis, idx, src)
def _segment_sum(src, seg, n):
    out = torch.zeros((n,) + src.shape[1:], dtype=src.dtype)
    return out.index_add_(0, seg, src)
def _pad(x, pw):
    flat = tuple(v for pair in reversed(pw) for v in pair)
    return torch.nn.functional.pad(x, flat)

kernel_name = 'interleave_layers__ssm_conv_h3__dense_activation_squared_relu__prompt'

def setup_inputs():

    _w = (lambda a: (lambda t: t.to(torch.bfloat16) if t.is_floating_point() else t)(torch.as_tensor(a)))
    def _A_setup():
        B, S, D = 1, 2048, 1024
        ks = 4
        return {
            "q": _w((lambda *s: torch.randn(*s, dtype=torch.bfloat16) * 0.05)(B, S, D)),
            "k": _w((lambda *s: torch.randn(*s, dtype=torch.bfloat16) * 0.8)(B, S, D)),
            "v": _w((lambda *s: torch.randn(*s, dtype=torch.bfloat16) * 0.8)(B, S, D)),
            "shift_k": _w((lambda *s: torch.randn(*s, dtype=torch.bfloat16) * 0.8)(D, ks) * 0.5),
            "ssm_k": _w((lambda *s: torch.randn(*s, dtype=torch.bfloat16) * 0.8)(D, S) * (1.0 / S ** 0.5)),
            "ssm_D": _w((lambda *s: torch.randn(*s, dtype=torch.bfloat16) * 0.8)(D)),
        }
    _A_in = _A_setup()

    def _B_setup():
        B, S, D, F = 1, 2048, 1024, 3584
        return {
            "x": _w((lambda *s: torch.randn(*s, dtype=torch.bfloat16) * 0.05)(B, S, D)),
            "w1": _w((lambda *s: torch.randn(*s, dtype=torch.bfloat16) * 0.05)(D, F)),
            "b1": _w((lambda *s: torch.randn(*s, dtype=torch.bfloat16) * 0.4)(F)),
            "w2": _w((lambda *s: torch.randn(*s, dtype=torch.bfloat16) * 0.05)(F, D)),
            "b2": _w((lambda *s: torch.randn(*s, dtype=torch.bfloat16) * 3.2)(D)),
        }
    _B_in = _B_setup()

    return {
        "A_q": _A_in["q"],
        "A_k": _A_in["k"],
        "A_v": _A_in["v"],
        "A_shift_k": _A_in["shift_k"],
        "A_ssm_k": _A_in["ssm_k"],
        "A_ssm_D": _A_in["ssm_D"],
        "B_x": _B_in["x"],
        "B_w1": _B_in["w1"],
        "B_b1": _B_in["b1"],
        "B_w2": _B_in["w2"],
        "B_b2": _B_in["b2"],
    }

def reference(A_q, A_k, A_v, A_shift_k, A_ssm_k, A_ssm_D, B_x, B_w1, B_b1, B_w2, B_b2):
    def _A_ref(q, k, v, shift_k, ssm_k, ssm_D):
        B, S, D = q.shape
        ks = shift_k.shape[-1]
        k_pad = _pad(k, ((0, 0), (ks - 1, 0), (0, 0)))
        k_shift = torch.zeros_like(k)
        for t in range(ks):
            k_shift = k_shift + k_pad[:, t:t + S, :] * shift_k[:, ks - 1 - t][None, None, :]
        kv = k_shift * v
        L = 2 * S
        kv_pad = _pad(kv, ((0, 0), (0, S), (0, 0)))
        kf_pad = _pad(ssm_k, ((0, 0), (0, S)))
        kv_f = (lambda x, axes=(-2,-1): torch.fft.rfft2(x.float(), dim=axes))(kv_pad[:, None, :, :], axes=(1, 2))
        kf_f = (lambda x, axes=(-2,-1): torch.fft.rfft2(x.float(), dim=axes))(kf_pad[:, None, :], axes=(1, 2))
        kf_f = (lambda x, *d: x.permute(*d))(kf_f, 1, 2, 0)
        y_f = kv_f * kf_f[None, :, :, :]
        y = (lambda x, s, axes=(-2,-1): torch.fft.irfft2(x, s=s, dim=axes).to(torch.bfloat16))(y_f, (1, L), axes=(1, 2))[:, 0, :S, :]
        y = y + kv * ssm_D[None, None, :]
        return q * y

    def _B_ref(x, w1, b1, w2, b2):
        h = torch.einsum("bsd,df->bsf", x, w1) + b1
        zero = torch.zeros_like(h)
        r = torch.where(h > zero, h, zero)
        h = r * r
        out = torch.einsum("bsf,fd->bsd", h, w2) + b2
        return out

    x = A_q
    x = x + _A_ref(_layernorm(x, axis=-1), A_k, A_v, A_shift_k, A_ssm_k, A_ssm_D)
    x = x + _B_ref(_layernorm(x, axis=-1), B_w1, B_b1, B_w2, B_b2)
    x = x + _A_ref(_layernorm(x, axis=-1), A_k, A_v, A_shift_k, A_ssm_k, A_ssm_D)
    x = x + _B_ref(_layernorm(x, axis=-1), B_w1, B_b1, B_w2, B_b2)
    return x
```

```asm
; @launch grid=(256,1,1) block=(256,1,1) lds=136192
.amdgcn_target "amdgcn-amd-amdhsa--gfx950"
.text
.globl interleave_layers__ssm_conv_h3__dense_activation_squared_relu__prompt_kernel
.p2align 8
.type interleave_layers__ssm_conv_h3__dense_activation_squared_relu__prompt_kernel,@function
interleave_layers__ssm_conv_h3__dense_activation_squared_relu__prompt_kernel:
    s_cmp_ge_u32 s2, 256
    s_cbranch_scc1 L_end
    s_mov_b32 s76, 0
    s_and_b32 s18, s2, 7
    s_lshr_b32 s19, s2, 3
    s_lshr_b32 s16, s18, 1
    s_lshl_b32 s16, s16, 2
    s_lshr_b32 s17, s19, 3
    s_add_u32 s16, s16, s17
    s_and_b32 s17, s18, 1
    s_lshl_b32 s17, s17, 3
    s_and_b32 s19, s19, 7
    s_add_u32 s17, s17, s19
    s_lshl_b32 s70, s16, 4
    s_add_u32 s70, s70, s17
    s_lshl_b32 s70, s70, 2
    s_and_b32 s77, s2, 7
    s_lshl_b32 s77, s77, 10
    s_lshl_b32 s79, s16, 8
    s_lshl_b32 s78, s17, 2
    s_add_u32 s78, s78, s79
    s_and_b32 s71, s78, 0xffe0
    s_mov_b32 s60, 0
    s_mov_b32 s61, 20971520
    s_mov_b32 s62, 75497472
    s_mov_b32 s63, 41943040
    s_load_dwordx4 s[4:7], s[0:1], 8
    s_load_dwordx4 s[8:11], s[0:1], 24
    s_load_dwordx2 s[12:13], s[0:1], 40
    s_load_dwordx2 s[14:15], s[0:1], 104
    s_load_dwordx4 s[52:55], s[0:1], 56
    s_load_dwordx2 s[56:57], s[0:1], 72
    v_lshrrev_b32 v4, 6, v0
    v_and_b32 v2, 63, v0
    v_lshlrev_b32 v3, 4, v2
    v_readfirstlane_b32 s20, v4
    s_and_b32 s58, s2, 7
    s_lshr_b32 s59, s2, 3
    v_and_b32 v124, 31, v0
    v_lshrrev_b32 v7, 5, v0
    s_lshl_b32 s18, s59, 17
    v_lshlrev_b32 v9, 14, v7
    v_lshl_add_u32 v9, v124, 3, v9
    v_add_u32 v9, s18, v9
    s_lshl_b32 s19, s58, 8
    v_subrev_u32 v4, 6144, v9
    v_and_b32 v4, 0x7fffffff, v4
    v_lshlrev_b32 v6, 5, v124
    s_lshl_b32 s36, s58, 10
    s_waitcnt lgkmcnt(0)
    s_mov_b32 s40, s4
    s_and_b32 s41, s5, 0xffff
    s_mov_b32 s42, 4194304
    s_mov_b32 s43, 0x20000
    s_mov_b32 s24, s6
    s_and_b32 s25, s7, 0xffff
    s_mov_b32 s26, 4194304
    s_mov_b32 s27, 0x20000
    s_mov_b32 s28, s8
    s_and_b32 s29, s9, 0xffff
    s_mov_b32 s30, 8192
    s_mov_b32 s31, 0x20000
    s_mov_b32 s32, s14
    s_and_b32 s33, s15, 0xffff
    s_mov_b32 s34, 268435456
    s_mov_b32 s35, 0x20000
    v_add_u32 v5, 0, v4
    buffer_load_dwordx2 v[10:11], v5, s[40:43], s19 offen
    v_add_u32 v5, 2048, v4
    buffer_load_dwordx2 v[12:13], v5, s[40:43], s19 offen
    v_add_u32 v5, 4096, v4
    buffer_load_dwordx2 v[14:15], v5, s[40:43], s19 offen
    v_add_u32 v5, 0, v9
    buffer_load_dwordx2 v[16:17], v5, s[40:43], s19 offen offset:0
    buffer_load_dwordx2 v[32:33], v5, s[24:27], s19 offen offset:0
    buffer_load_dwordx2 v[18:19], v5, s[40:43], s19 offen offset:2048
    buffer_load_dwordx2 v[34:35], v5, s[24:27], s19 offen offset:2048
    v_add_u32 v5, 4096, v9
    buffer_load_dwordx2 v[20:21], v5, s[40:43], s19 offen offset:0
    buffer_load_dwordx2 v[36:37], v5, s[24:27], s19 offen offset:0
    buffer_load_dwordx2 v[22:23], v5, s[40:43], s19 offen offset:2048
    buffer_load_dwordx2 v[38:39], v5, s[24:27], s19 offen offset:2048
    v_add_u32 v5, 8192, v9
    buffer_load_dwordx2 v[24:25], v5, s[40:43], s19 offen offset:0
    buffer_load_dwordx2 v[40:41], v5, s[24:27], s19 offen offset:0
    buffer_load_dwordx2 v[26:27], v5, s[40:43], s19 offen offset:2048
    buffer_load_dwordx2 v[42:43], v5, s[24:27], s19 offen offset:2048
    v_add_u32 v5, 12288, v9
    buffer_load_dwordx2 v[28:29], v5, s[40:43], s19 offen offset:0
    buffer_load_dwordx2 v[44:45], v5, s[24:27], s19 offen offset:0
    buffer_load_dwordx2 v[30:31], v5, s[40:43], s19 offen offset:2048
    buffer_load_dwordx2 v[46:47], v5, s[24:27], s19 offen offset:2048
    buffer_load_dwordx4 v[48:51], v6, s[28:31], s36 offen
    buffer_load_dwordx4 v[52:55], v6, s[28:31], s36 offen offset:16
    s_add_u32 s4, s14, 81264640
    s_addc_u32 s5, s15, 0
    s_load_dword s64, s[4:5], 0
    s_lshl_b32 s21, s58, 7
    s_lshl_b32 s18, s59, 2
    s_add_u32 s21, s21, s18
    s_lshl_b32 s18, s21, 1
    s_add_u32 s12, s12, s18
    s_addc_u32 s13, s13, 0
    s_load_dwordx2 s[44:45], s[12:13], 0
    s_mov_b32 s68, 0x05040100
    s_mov_b32 s69, 0x07060302
    v_and_b32 v112, 15, v2
    v_lshrrev_b32 v113, 4, v2
    s_cmp_lt_u32 s20, 2
    s_cbranch_scc1 L_w1l
    s_sub_u32 s48, s20, 2
    s_mov_b32 s28, s10
    s_and_b32 s29, s11, 0xffff
    s_mov_b32 s30, 4194304
    s_mov_b32 s31, 0x20000
    s_lshl_b32 s46, s48, 1
    s_add_u32 s46, s46, s21
    s_lshl_b32 s46, s46, 12
    buffer_load_dwordx4 v[128:131], v3, s[28:31], s46 offen offset:0
    buffer_load_dword v160, v3, s[28:31], s46 offen offset:16
    buffer_load_dwordx4 v[132:135], v3, s[28:31], s46 offen offset:1024
    buffer_load_dword v161, v3, s[28:31], s46 offen offset:1040
    buffer_load_dwordx4 v[136:139], v3, s[28:31], s46 offen offset:2048
    buffer_load_dword v162, v3, s[28:31], s46 offen offset:2064
    buffer_load_dwordx4 v[140:143], v3, s[28:31], s46 offen offset:3072
    buffer_load_dword v163, v3, s[28:31], s46 offen offset:3088
    s_add_u32 s46, s46, 4096
    buffer_load_dwordx4 v[144:147], v3, s[28:31], s46 offen offset:0
    buffer_load_dword v164, v3, s[28:31], s46 offen offset:16
    buffer_load_dwordx4 v[148:151], v3, s[28:31], s46 offen offset:1024
    buffer_load_dword v165, v3, s[28:31], s46 offen offset:1040
    buffer_load_dwordx4 v[152:155], v3, s[28:31], s46 offen offset:2048
    buffer_load_dword v166, v3, s[28:31], s46 offen offset:2064
    buffer_load_dwordx4 v[156:159], v3, s[28:31], s46 offen offset:3072
    buffer_load_dword v167, v3, s[28:31], s46 offen offset:3088
    s_add_u32 s46, s46, 4096
    s_waitcnt vmcnt(16)
    s_branch L_kv
L_w1l:
    s_waitcnt vmcnt(0)
L_kv:
    v_mul_u32_u24 v8, 576, v124
    v_lshlrev_b32 v9, 4, v7
    v_sub_u32 v8, v8, v9
    v_add_u32 v8, 65648, v8
    v_lshlrev_b32 v56, 16, v48
    v_and_b32 v57, 0xffff0000, v48
    v_lshlrev_b32 v58, 16, v49
    v_and_b32 v59, 0xffff0000, v49
    v_lshlrev_b32 v60, 16, v50
    v_and_b32 v61, 0xffff0000, v50
    v_lshlrev_b32 v62, 16, v51
    v_and_b32 v63, 0xffff0000, v51
    v_lshlrev_b32 v64, 16, v52
    v_and_b32 v65, 0xffff0000, v52
    v_lshlrev_b32 v66, 16, v53
    v_and_b32 v67, 0xffff0000, v53
    v_lshlrev_b32 v68, 16, v54
    v_and_b32 v69, 0xffff0000, v54
    v_lshlrev_b32 v70, 16, v55
    v_and_b32 v71, 0xffff0000, v55
    v_lshlrev_b32 v72, 16, v10
    v_lshlrev_b32 v73, 16, v12
    v_lshlrev_b32 v74, 16, v14
    v_lshlrev_b32 v75, 16, v16
    v_lshlrev_b32 v76, 16, v18
    v_lshlrev_b32 v77, 16, v20
    v_lshlrev_b32 v78, 16, v22
    v_lshlrev_b32 v79, 16, v24
    v_lshlrev_b32 v80, 16, v26
    v_lshlrev_b32 v81, 16, v28
    v_lshlrev_b32 v82, 16, v30
    v_mul_f32 v84, v59, v72
    v_lshlrev_b32 v92, 16, v32
    v_fmac_f32 v84, v58, v73
    v_fmac_f32 v84, v57, v74
    v_fmac_f32 v84, v56, v75
    v_mul_f32 v84, v84, v92
    v_mul_f32 v85, v59, v73
    v_lshlrev_b32 v92, 16, v34
    v_fmac_f32 v85, v58, v74
    v_fmac_f32 v85, v57, v75
    v_fmac_f32 v85, v56, v76
    v_mul_f32 v85, v85, v92
    v_mul_f32 v86, v59, v74
    v_lshlrev_b32 v92, 16, v36
    v_fmac_f32 v86, v58, v75
    v_fmac_f32 v86, v57, v76
    v_fmac_f32 v86, v56, v77
    v_mul_f32 v86, v86, v92
    v_mul_f32 v87, v59, v75
    v_lshlrev_b32 v92, 16, v38
    v_fmac_f32 v87, v58, v76
    v_fmac_f32 v87, v57, v77
    v_fmac_f32 v87, v56, v78
    v_mul_f32 v87, v87, v92
    v_mul_f32 v88, v59, v76
    v_lshlrev_b32 v92, 16, v40
    v_fmac_f32 v88, v58, v77
    v_fmac_f32 v88, v57, v78
    v_fmac_f32 v88, v56, v79
    v_mul_f32 v88, v88, v92
    v_mul_f32 v89, v59, v77
    v_lshlrev_b32 v92, 16, v42
    v_fmac_f32 v89, v58, v78
    v_fmac_f32 v89, v57, v79
    v_fmac_f32 v89, v56, v80
    v_mul_f32 v89, v89, v92
    v_mul_f32 v90, v59, v78
    v_lshlrev_b32 v92, 16, v44
    v_fmac_f32 v90, v58, v79
    v_fmac_f32 v90, v57, v80
    v_fmac_f32 v90, v56, v81
    v_mul_f32 v90, v90, v92
    v_mul_f32 v91, v59, v79
    v_lshlrev_b32 v92, 16, v46
    v_fmac_f32 v91, v58, v80
    v_fmac_f32 v91, v57, v81
    v_fmac_f32 v91, v56, v82
    v_mul_f32 v91, v91, v92
    v_cvt_pk_bf16_f32 v96, v91, v90
    v_cvt_pk_bf16_f32 v97, v89, v88
    v_cvt_pk_bf16_f32 v98, v87, v86
    v_cvt_pk_bf16_f32 v99, v85, v84
    ds_write_b128 v8, v[96:99] offset:0
    v_and_b32 v72, 0xffff0000, v10
    v_and_b32 v73, 0xffff0000, v12
    v_and_b32 v74, 0xffff0000, v14
    v_and_b32 v75, 0xffff0000, v16
    v_and_b32 v76, 0xffff0000, v18
    v_and_b32 v77, 0xffff0000, v20
    v_and_b32 v78, 0xffff0000, v22
    v_and_b32 v79, 0xffff0000, v24
    v_and_b32 v80, 0xffff0000, v26
    v_and_b32 v81, 0xffff0000, v28
    v_and_b32 v82, 0xffff0000, v30
    v_mul_f32 v84, v63, v72
    v_and_b32 v92, 0xffff0000, v32
    v_fmac_f32 v84, v62, v73
    v_fmac_f32 v84, v61, v74
    v_fmac_f32 v84, v60, v75
    v_mul_f32 v84, v84, v92
    v_mul_f32 v85, v63, v73
    v_and_b32 v92, 0xffff0000, v34
    v_fmac_f32 v85, v62, v74
    v_fmac_f32 v85, v61, v75
    v_fmac_f32 v85, v60, v76
    v_mul_f32 v85, v85, v92
    v_mul_f32 v86, v63, v74
    v_and_b32 v92, 0xffff0000, v36
    v_fmac_f32 v86, v62, v75
    v_fmac_f32 v86, v61, v76
    v_fmac_f32 v86, v60, v77
    v_mul_f32 v86, v86, v92
    v_mul_f32 v87, v63, v75
    v_and_b32 v92, 0xffff0000, v38
    v_fmac_f32 v87, v62, v76
    v_fmac_f32 v87, v61, v77
    v_fmac_f32 v87, v60, v78
    v_mul_f32 v87, v87, v92
    v_mul_f32 v88, v63, v76
    v_and_b32 v92, 0xffff0000, v40
    v_fmac_f32 v88, v62, v77
    v_fmac_f32 v88, v61, v78
    v_fmac_f32 v88, v60, v79
    v_mul_f32 v88, v88, v92
    v_mul_f32 v89, v63, v77
    v_and_b32 v92, 0xffff0000, v42
    v_fmac_f32 v89, v62, v78
    v_fmac_f32 v89, v61, v79
    v_fmac_f32 v89, v60, v80
    v_mul_f32 v89, v89, v92
    v_mul_f32 v90, v63, v78
    v_and_b32 v92, 0xffff0000, v44
    v_fmac_f32 v90, v62, v79
    v_fmac_f32 v90, v61, v80
    v_fmac_f32 v90, v60, v81
    v_mul_f32 v90, v90, v92
    v_mul_f32 v91, v63, v79
    v_and_b32 v92, 0xffff0000, v46
    v_fmac_f32 v91, v62, v80
    v_fmac_f32 v91, v61, v81
    v_fmac_f32 v91, v60, v82
    v_mul_f32 v91, v91, v92
    v_cvt_pk_bf16_f32 v100, v91, v90
    v_cvt_pk_bf16_f32 v101, v89, v88
    v_cvt_pk_bf16_f32 v102, v87, v86
    v_cvt_pk_bf16_f32 v103, v85, v84
    ds_write_b128 v8, v[100:103] offset:144
    v_lshlrev_b32 v72, 16, v11
    v_lshlrev_b32 v73, 16, v13
    v_lshlrev_b32 v74, 16, v15
    v_lshlrev_b32 v75, 16, v17
    v_lshlrev_b32 v76, 16, v19
    v_lshlrev_b32 v77, 16, v21
    v_lshlrev_b32 v78, 16, v23
    v_lshlrev_b32 v79, 16, v25
    v_lshlrev_b32 v80, 16, v27
    v_lshlrev_b32 v81, 16, v29
    v_lshlrev_b32 v82, 16, v31
    v_mul_f32 v84, v67, v72
    v_lshlrev_b32 v92, 16, v33
    v_fmac_f32 v84, v66, v73
    v_fmac_f32 v84, v65, v74
    v_fmac_f32 v84, v64, v75
    v_mul_f32 v84, v84, v92
    v_mul_f32 v85, v67, v73
    v_lshlrev_b32 v92, 16, v35
    v_fmac_f32 v85, v66, v74
    v_fmac_f32 v85, v65, v75
    v_fmac_f32 v85, v64, v76
    v_mul_f32 v85, v85, v92
    v_mul_f32 v86, v67, v74
    v_lshlrev_b32 v92, 16, v37
    v_fmac_f32 v86, v66, v75
    v_fmac_f32 v86, v65, v76
    v_fmac_f32 v86, v64, v77
    v_mul_f32 v86, v86, v92
    v_mul_f32 v87, v67, v75
    v_lshlrev_b32 v92, 16, v39
    v_fmac_f32 v87, v66, v76
    v_fmac_f32 v87, v65, v77
    v_fmac_f32 v87, v64, v78
    v_mul_f32 v87, v87, v92
    v_mul_f32 v88, v67, v76
    v_lshlrev_b32 v92, 16, v41
    v_fmac_f32 v88, v66, v77
    v_fmac_f32 v88, v65, v78
    v_fmac_f32 v88, v64, v79
    v_mul_f32 v88, v88, v92
    v_mul_f32 v89, v67, v77
    v_lshlrev_b32 v92, 16, v43
    v_fmac_f32 v89, v66, v78
    v_fmac_f32 v89, v65, v79
    v_fmac_f32 v89, v64, v80
    v_mul_f32 v89, v89, v92
    v_mul_f32 v90, v67, v78
    v_lshlrev_b32 v92, 16, v45
    v_fmac_f32 v90, v66, v79
    v_fmac_f32 v90, v65, v80
    v_fmac_f32 v90, v64, v81
    v_mul_f32 v90, v90, v92
    v_mul_f32 v91, v67, v79
    v_lshlrev_b32 v92, 16, v47
    v_fmac_f32 v91, v66, v80
    v_fmac_f32 v91, v65, v81
    v_fmac_f32 v91, v64, v82
    v_mul_f32 v91, v91, v92
    v_cvt_pk_bf16_f32 v104, v91, v90
    v_cvt_pk_bf16_f32 v105, v89, v88
    v_cvt_pk_bf16_f32 v106, v87, v86
    v_cvt_pk_bf16_f32 v107, v85, v84
    ds_write_b128 v8, v[104:107] offset:288
    v_and_b32 v72, 0xffff0000, v11
    v_and_b32 v73, 0xffff0000, v13
    v_and_b32 v74, 0xffff0000, v15
    v_and_b32 v75, 0xffff0000, v17
    v_and_b32 v76, 0xffff0000, v19
    v_and_b32 v77, 0xffff0000, v21
    v_and_b32 v78, 0xffff0000, v23
    v_and_b32 v79, 0xffff0000, v25
    v_and_b32 v80, 0xffff0000, v27
    v_and_b32 v81, 0xffff0000, v29
    v_and_b32 v82, 0xffff0000, v31
    v_mul_f32 v84, v71, v72
    v_and_b32 v92, 0xffff0000, v33
    v_fmac_f32 v84, v70, v73
    v_fmac_f32 v84, v69, v74
    v_fmac_f32 v84, v68, v75
    v_mul_f32 v84, v84, v92
    v_mul_f32 v85, v71, v73
    v_and_b32 v92, 0xffff0000, v35
    v_fmac_f32 v85, v70, v74
    v_fmac_f32 v85, v69, v75
    v_fmac_f32 v85, v68, v76
    v_mul_f32 v85, v85, v92
    v_mul_f32 v86, v71, v74
    v_and_b32 v92, 0xffff0000, v37
    v_fmac_f32 v86, v70, v75
    v_fmac_f32 v86, v69, v76
    v_fmac_f32 v86, v68, v77
    v_mul_f32 v86, v86, v92
    v_mul_f32 v87, v71, v75
    v_and_b32 v92, 0xffff0000, v39
    v_fmac_f32 v87, v70, v76
    v_fmac_f32 v87, v69, v77
    v_fmac_f32 v87, v68, v78
    v_mul_f32 v87, v87, v92
    v_mul_f32 v88, v71, v76
    v_and_b32 v92, 0xffff0000, v41
    v_fmac_f32 v88, v70, v77
    v_fmac_f32 v88, v69, v78
    v_fmac_f32 v88, v68, v79
    v_mul_f32 v88, v88, v92
    v_mul_f32 v89, v71, v77
    v_and_b32 v92, 0xffff0000, v43
    v_fmac_f32 v89, v70, v78
    v_fmac_f32 v89, v69, v79
    v_fmac_f32 v89, v68, v80
    v_mul_f32 v89, v89, v92
    v_mul_f32 v90, v71, v78
    v_and_b32 v92, 0xffff0000, v45
    v_fmac_f32 v90, v70, v79
    v_fmac_f32 v90, v69, v80
    v_fmac_f32 v90, v68, v81
    v_mul_f32 v90, v90, v92
    v_mul_f32 v91, v71, v79
    v_and_b32 v92, 0xffff0000, v47
    v_fmac_f32 v91, v70, v80
    v_fmac_f32 v91, v69, v81
    v_fmac_f32 v91, v68, v82
    v_mul_f32 v91, v91, v92
    v_cvt_pk_bf16_f32 v108, v91, v90
    v_cvt_pk_bf16_f32 v109, v89, v88
    v_cvt_pk_bf16_f32 v110, v87, v86
    v_cvt_pk_bf16_f32 v111, v85, v84
    ds_write_b128 v8, v[108:111] offset:432
    s_mul_i32 s47, s20, 4608
    v_mov_b32 v70, 0
    v_mov_b32 v71, 0
    v_lshlrev_b32 v7, 3, v2
    v_add_u32 v7, s47, v7
    ds_write_b64 v7, v[70:71] offset:4096
    s_waitcnt lgkmcnt(0)
    s_barrier
    s_mul_i32 s64, s64, 0x9e3779b1
    s_add_u32 s64, s64, 0x7f4a7c15
    s_mov_b32 s65, 80740352
    s_cmp_ge_u32 s20, 2
    s_cbranch_scc1 L_w1s
    v_lshrrev_b32 v8, 3, v0
    v_mul_u32_u24 v8, 144, v8
    v_and_b32 v9, 7, v0
    v_lshl_add_u32 v8, v9, 4, v8
    v_add_u32 v8, 65536, v8
    v_lshlrev_b32 v9, 4, v0
    s_sub_u32 s18, 31, s59
    s_lshl_b32 s18, s18, 17
    s_lshl_b32 s19, s58, 14
    s_add_u32 s18, s18, s19
    s_add_u32 s18, s18, 75497472
    ds_read_b128 v[16:19], v8 offset:0
    ds_read_b128 v[20:23], v8 offset:2304
    ds_read_b128 v[24:27], v8 offset:4608
    ds_read_b128 v[28:31], v8 offset:6912
    ds_read_b128 v[32:35], v8 offset:9216
    ds_read_b128 v[36:39], v8 offset:11520
    ds_read_b128 v[40:43], v8 offset:13824
    ds_read_b128 v[44:47], v8 offset:16128
    s_waitcnt lgkmcnt(7)
    buffer_store_dwordx4 v[16:19], v9, s[32:35], s18 offen offset:0 sc1
    s_waitcnt lgkmcnt(6)
    buffer_store_dwordx4 v[20:23], v9, s[32:35], s18 offen offset:2048 sc1
    s_add_u32 s18, s18, 4096
    s_waitcnt lgkmcnt(5)
    buffer_store_dwordx4 v[24:27], v9, s[32:35], s18 offen offset:0 sc1
    s_waitcnt lgkmcnt(4)
    buffer_store_dwordx4 v[28:31], v9, s[32:35], s18 offen offset:2048 sc1
    s_add_u32 s18, s18, 4096
    s_waitcnt lgkmcnt(3)
    buffer_store_dwordx4 v[32:35], v9, s[32:35], s18 offen offset:0 sc1
    s_waitcnt lgkmcnt(2)
    buffer_store_dwordx4 v[36:39], v9, s[32:35], s18 offen offset:2048 sc1
    s_add_u32 s18, s18, 4096
    s_waitcnt lgkmcnt(1)
    buffer_store_dwordx4 v[40:43], v9, s[32:35], s18 offen offset:0 sc1
    s_waitcnt lgkmcnt(0)
    buffer_store_dwordx4 v[44:47], v9, s[32:35], s18 offen offset:2048 sc1
    s_add_u32 s18, s18, 4096
    s_lshl_b32 s73, s58, 8
    s_lshl_b32 s72, s59, 2
    s_add_u32 s72, s72, s73
    s_add_u32 s66, s72, s65
    s_add_u32 s66, s66, 0
    v_mov_b32 v12, s64
    v_lshlrev_b32 v13, 10, v2
    s_waitcnt vmcnt(0)
    s_barrier
    s_cmp_lg_u32 s20, 0
    s_cbranch_scc1 L_sg478
    s_mov_b64 exec, 1
    buffer_store_dword v12, v13, s[32:35], s66 offen sc1
    s_mov_b64 exec, -1
L_sg478:
    s_cmp_lg_u32 s20, 0
    s_cbranch_scc1 L_wt484d
    s_add_u32 s66, s73, s65
    s_add_u32 s66, s66, 0
    v_and_b32 v13, 112, v3
    s_mov_b32 s67, 0x40000
L_wt484:
    buffer_load_dwordx4 v[8:11], v13, s[32:35], s66 offen sc1
    s_waitcnt vmcnt(0)
    v_xor_b32 v8, s64, v8
    v_xor_b32 v9, s64, v9
    v_xor_b32 v10, s64, v10
    v_xor_b32 v11, s64, v11
    v_or3_b32 v8, v8, v9, v10
    v_or_b32 v12, v8, v11
    v_cmp_ne_u32 vcc, 0, v12
    s_cmp_eq_u64 vcc, 0
    s_cbranch_scc1 L_wt484d
    s_sub_u32 s67, s67, 1
    s_cmp_lg_u32 s67, 0
    s_cbranch_scc1 L_wt484
L_wt484d:
    s_barrier
    s_branch L_cv
L_w1s:
    s_barrier
    s_mul_i32 s48, s48, 16640
    s_add_u32 s48, s48, 18432
    v_add_u32 v9, s48, v3
    s_waitcnt vmcnt(0)
    v_mov_b32 v116, 0
    v_mov_b32 v117, 0
    v_mov_b32 v118, 0
    v_mov_b32 v119, 0
    v_mov_b32 v120, 0
    v_mov_b32 v121, 0
    v_mov_b32 v122, 0
    ds_write_b128 v9, v[128:131] offset:32
    v_alignbit_b32 v56, v129, v128, 16
    v_alignbit_b32 v57, v130, v129, 16
    v_alignbit_b32 v58, v131, v130, 16
    v_alignbit_b32 v59, v160, v131, 16
    ds_write_b128 v9, v[56:59] offset:4192
    ds_write_b128 v9, v[132:135] offset:1056
    v_alignbit_b32 v60, v133, v132, 16
    v_alignbit_b32 v61, v134, v133, 16
    v_alignbit_b32 v62, v135, v134, 16
    v_alignbit_b32 v63, v161, v135, 16
    ds_write_b128 v9, v[60:63] offset:5216
    ds_write_b128 v9, v[136:139] offset:2080
    v_alignbit_b32 v64, v137, v136, 16
    v_alignbit_b32 v65, v138, v137, 16
    v_alignbit_b32 v66, v139, v138, 16
    v_alignbit_b32 v67, v162, v139, 16
    ds_write_b128 v9, v[64:67] offset:6240
    ds_write_b128 v9, v[140:143] offset:3104
    v_alignbit_b32 v68, v141, v140, 16
    v_alignbit_b32 v69, v142, v141, 16
    v_alignbit_b32 v70, v143, v142, 16
    v_alignbit_b32 v71, v163, v143, 16
    ds_write_b128 v9, v[68:71] offset:7264
    v_lshlrev_b32 v123, 16, v128
    s_mov_b64 exec, 1
    ds_write_b128 v9, v[116:119] offset:0
    ds_write_b128 v9, v[116:119] offset:16
    ds_write_b128 v9, v[116:119] offset:4160
    ds_write_b128 v9, v[120:123] offset:4176
    s_mov_b64 exec, -1
    s_waitcnt lgkmcnt(0)
    ds_write_b128 v9, v[144:147] offset:8352
    v_alignbit_b32 v56, v145, v144, 16
    v_alignbit_b32 v57, v146, v145, 16
    v_alignbit_b32 v58, v147, v146, 16
    v_alignbit_b32 v59, v164, v147, 16
    ds_write_b128 v9, v[56:59] offset:12512
    ds_write_b128 v9, v[148:151] offset:9376
    v_alignbit_b32 v60, v149, v148, 16
    v_alignbit_b32 v61, v150, v149, 16
    v_alignbit_b32 v62, v151, v150, 16
    v_alignbit_b32 v63, v165, v151, 16
    ds_write_b128 v9, v[60:63] offset:13536
    ds_write_b128 v9, v[152:155] offset:10400
    v_alignbit_b32 v64, v153, v152, 16
    v_alignbit_b32 v65, v154, v153, 16
    v_alignbit_b32 v66, v155, v154, 16
    v_alignbit_b32 v67, v166, v155, 16
    ds_write_b128 v9, v[64:67] offset:14560
    ds_write_b128 v9, v[156:159] offset:11424
    v_alignbit_b32 v68, v157, v156, 16
    v_alignbit_b32 v69, v158, v157, 16
    v_alignbit_b32 v70, v159, v158, 16
    v_alignbit_b32 v71, v167, v159, 16
    ds_write_b128 v9, v[68:71] offset:15584
    v_lshlrev_b32 v123, 16, v144
    s_mov_b64 exec, 1
    ds_write_b128 v9, v[116:119] offset:8320
    ds_write_b128 v9, v[116:119] offset:8336
    ds_write_b128 v9, v[116:119] offset:12480
    ds_write_b128 v9, v[120:123] offset:12496
    s_mov_b64 exec, -1
    s_waitcnt lgkmcnt(0)
    s_lshl_b32 s47, s20, 8
    s_add_u32 s47, s47, s2
    s_cmp_ge_u32 s47, 540
    s_cbranch_scc1 L_wj
    s_mov_b32 s28, s54
    s_and_b32 s29, s55, 0xffff
    s_mov_b32 s30, 7168
    s_mov_b32 s31, 0x20000
    v_lshlrev_b32 v8, 2, v2
    s_lshl_b32 s47, s2, 8
    buffer_load_dword v9, v8, s[28:31], s47 offen
    v_and_b32 v10, 3, v2
    v_lshlrev_b32 v10, 7, v10
    v_and_b32 v11, 60, v2
    v_add_u32 v10, v10, v11
    s_lshl_b32 s47, s2, 9
    s_add_u32 s47, s47, 79691776
    s_waitcnt vmcnt(0)
    v_lshlrev_b32 v11, 16, v9
    v_and_b32 v12, 0xffff0000, v9
    buffer_store_dword v11, v10, s[32:35], s47 offen sc1
    buffer_store_dword v12, v10, s[32:35], s47 offen offset:64 sc1
L_wj:
    s_barrier
L_cv:
    s_add_u32 s19, s20, s21
    s_lshl_b32 s19, s19, 7
    s_add_u32 s19, s19, 75497472
    s_mul_i32 s18, s20, 4608
    v_lshrrev_b32 v4, 3, v2
    v_lshlrev_b32 v4, 17, v4
    v_and_b32 v5, 7, v2
    v_lshl_add_u32 v4, v5, 4, v4
    s_add_u32 m0, s18, 0
    s_add_u32 s36, s19, 0
    buffer_load_dwordx4 v4, s[32:35], s36 offen sc1 lds
    s_add_u32 m0, s18, 1024
    s_add_u32 s36, s19, 1048576
    buffer_load_dwordx4 v4, s[32:35], s36 offen sc1 lds
    s_add_u32 m0, s18, 2048
    s_add_u32 s36, s19, 2097152
    buffer_load_dwordx4 v4, s[32:35], s36 offen sc1 lds
    s_add_u32 m0, s18, 3072
    s_add_u32 s36, s19, 3145728
    buffer_load_dwordx4 v4, s[32:35], s36 offen sc1 lds
    s_mov_b32 s28, s52
    s_and_b32 s29, s53, 0xffff
    s_mov_b32 s30, 7340032
    s_mov_b32 s31, 0x20000
    s_lshl_b32 s46, s20, 8
    s_add_u32 s46, s46, s2
    s_cmp_ge_u32 s46, 896
    s_cselect_b32 s30, 0, s30
    s_and_b32 s22, s2, 31
    s_lshr_b32 s23, s46, 5
    s_mul_i32 s46, s22, 229376
    s_lshl_b32 s47, s23, 8
    s_add_u32 s46, s46, s47
    v_mul_u32_u24 v114, 57344, v113
    v_lshl_add_u32 v114, v112, 4, v114
    s_add_u32 s47, s46, 0
    buffer_load_dwordx4 v[80:83], v114, s[28:31], s47 offen
    s_add_u32 s47, s46, 7168
    buffer_load_dwordx4 v[84:87], v114, s[28:31], s47 offen
    s_add_u32 s47, s46, 14336
    buffer_load_dwordx4 v[88:91], v114, s[28:31], s47 offen
    s_add_u32 s47, s46, 21504
    buffer_load_dwordx4 v[92:95], v114, s[28:31], s47 offen
    s_add_u32 s47, s46, 28672
    buffer_load_dwordx4 v[96:99], v114, s[28:31], s47 offen
    s_add_u32 s47, s46, 35840
    buffer_load_dwordx4 v[100:103], v114, s[28:31], s47 offen
    s_add_u32 s47, s46, 43008
    buffer_load_dwordx4 v[104:107], v114, s[28:31], s47 offen
    s_add_u32 s47, s46, 50176
    buffer_load_dwordx4 v[108:111], v114, s[28:31], s47 offen
    s_load_dwordx2 s[4:5], s[0:1], 0
    v_and_b32 v27, 7, v2
    v_lshrrev_b32 v28, 3, v2
    s_lshl_b32 s52, s20, 9
    v_lshlrev_b32 v14, 11, v27
    v_lshl_add_u32 v14, v28, 4, v14
    v_add_u32 v14, s52, v14
    s_lshl_b32 s52, s20, 12
    v_lshlrev_b32 v15, 7, v28
    v_lshl_add_u32 v15, v27, 3, v15
    v_add_u32 v15, s52, v15
    s_lshl_b32 s52, s20, 2
    v_lshlrev_b32 v24, 5, v27
    v_add_u32 v24, 135168, v24
    v_lshrrev_b32 v25, 5, v2
    v_lshl_add_u32 v25, v25, 4, v24
    v_add_u32 v25, s52, v25
    s_lshl_b32 s52, s20, 16
    v_lshrrev_b32 v26, 2, v28
    v_lshlrev_b32 v26, 13, v26
    v_and_b32 v28, 3, v28
    v_lshl_add_u32 v26, v28, 8, v26
    v_lshl_add_u32 v26, v27, 4, v26
    v_add_u32 v26, s52, v26
    s_lshl_b32 s53, s16, 18
    s_lshr_b32 s52, s17, 1
    s_lshl_b32 s52, s52, 10
    s_add_u32 s53, s53, s52
    s_and_b32 s52, s17, 1
    s_lshl_b32 s52, s52, 7
    s_add_u32 s53, s53, s52
    s_add_u32 s53, s53, s61
    s_lshl_b32 s52, s16, 4
    s_add_u32 s52, s52, s17
    s_lshl_b32 s52, s52, 14
    s_waitcnt lgkmcnt(0)
    s_mov_b32 s24, s4
    s_and_b32 s25, s5, 0xffff
    s_mov_b32 s26, 4194304
    s_mov_b32 s27, 0x20000
    buffer_load_dwordx4 v[64:67], v14, s[24:27], s52 offen offset:0
    buffer_load_dwordx4 v[68:71], v14, s[24:27], s52 offen offset:128
    buffer_load_dwordx4 v[72:75], v14, s[24:27], s52 offen offset:256
    buffer_load_dwordx4 v[76:79], v14, s[24:27], s52 offen offset:384
    s_mul_i32 s47, s20, 4608
    s_mul_i32 s48, s20, 8320
    s_add_u32 s48, s48, 18432
    s_lshr_b32 s49, s20, 1
    s_cmp_eq_u32 s49, 0
    s_cselect_b32 s49, s44, s45
    s_lshl_b32 s50, s49, 16
    s_and_b32 s49, s49, 0xffff0000
    s_bitcmp1_b32 s20, 0
    s_cselect_b32 s49, s49, s50
    v_add_u32 v5, 1, v112
    v_lshrrev_b32 v5, 1, v5
    v_lshl_add_u32 v5, v113, 2, v5
    v_lshlrev_b32 v5, 2, v5
    v_and_b32 v6, 1, v112
    v_xor_b32 v6, 1, v6
    v_mul_u32_u24 v6, 4160, v6
    v_add3_u32 v5, v5, v6, s48
    v_add_u32 v6, 1024, v5
    v_add_u32 v7, 2048, v5
    v_add_u32 v8, 3072, v5
    v_lshlrev_b32 v9, 5, v112
    v_sub_u32 v9, 480, v9
    v_lshl_add_u32 v9, v113, 4, v9
    v_add_u32 v9, s47, v9
    v_accvgpr_write_b32 a0, 0
    v_accvgpr_write_b32 a1, 0
    v_accvgpr_write_b32 a2, 0
    v_accvgpr_write_b32 a3, 0
    v_accvgpr_write_b32 a4, 0
    v_accvgpr_write_b32 a5, 0
    v_accvgpr_write_b32 a6, 0
    v_accvgpr_write_b32 a7, 0
    v_accvgpr_write_b32 a8, 0
    v_accvgpr_write_b32 a9, 0
    v_accvgpr_write_b32 a10, 0
    v_accvgpr_write_b32 a11, 0
    v_accvgpr_write_b32 a12, 0
    v_accvgpr_write_b32 a13, 0
    v_accvgpr_write_b32 a14, 0
    v_accvgpr_write_b32 a15, 0
    v_accvgpr_write_b32 a16, 0
    v_accvgpr_write_b32 a17, 0
    v_accvgpr_write_b32 a18, 0
    v_accvgpr_write_b32 a19, 0
    v_accvgpr_write_b32 a20, 0
    v_accvgpr_write_b32 a21, 0
    v_accvgpr_write_b32 a22, 0
    v_accvgpr_write_b32 a23, 0
    v_accvgpr_write_b32 a24, 0
    v_accvgpr_write_b32 a25, 0
    v_accvgpr_write_b32 a26, 0
    v_accvgpr_write_b32 a27, 0
    v_accvgpr_write_b32 a28, 0
    v_accvgpr_write_b32 a29, 0
    v_accvgpr_write_b32 a30, 0
    v_accvgpr_write_b32 a31, 0
    s_waitcnt vmcnt(12)
    ds_read_b128 v[160:163], v9 offset:3584
    ds_read2_b32 v[128:129], v5 offset0:0 offset1:1
    ds_read2_b32 v[130:131], v5 offset0:2 offset1:3
    ds_read_b128 v[164:167], v9 offset:3072
    ds_read2_b32 v[132:133], v5 offset0:128 offset1:129
    ds_read2_b32 v[134:135], v5 offset0:130 offset1:131
    ds_read_b128 v[168:171], v9 offset:2560
    ds_read2_b32 v[136:137], v6 offset0:0 offset1:1
    ds_read2_b32 v[138:139], v6 offset0:2 offset1:3
    ds_read_b128 v[172:175], v9 offset:2048
    ds_read2_b32 v[140:141], v6 offset0:128 offset1:129
    ds_read2_b32 v[142:143], v6 offset0:130 offset1:131
    ds_read_b128 v[176:179], v9 offset:1536
    ds_read2_b32 v[144:145], v7 offset0:0 offset1:1
    ds_read2_b32 v[146:147], v7 offset0:2 offset1:3
    ds_read_b128 v[180:183], v9 offset:1024
    ds_read2_b32 v[148:149], v7 offset0:128 offset1:129
    ds_read2_b32 v[150:151], v7 offset0:130 offset1:131
    ds_read_b128 v[184:187], v9 offset:512
    ds_read2_b32 v[152:153], v8 offset0:0 offset1:1
    ds_read2_b32 v[154:155], v8 offset0:2 offset1:3
    ds_read_b128 v[188:191], v9 offset:0
    ds_read2_b32 v[156:157], v8 offset0:128 offset1:129
    ds_read2_b32 v[158:159], v8 offset0:130 offset1:131
    s_mov_b32 s51, 4
L_cvl:
    s_waitcnt lgkmcnt(0)
    v_mfma_f32_16x16x32_bf16 a[0:3], v[128:131], v[160:163], a[0:3]
    ds_read_b128 v[224:227], v9 offset:3648
    v_mfma_f32_16x16x32_bf16 a[4:7], v[128:131], v[164:167], a[4:7]
    ds_read2_b32 v[192:193], v5 offset0:16 offset1:17
    v_mfma_f32_16x16x32_bf16 a[8:11], v[128:131], v[168:171], a[8:11]
    ds_read2_b32 v[194:195], v5 offset0:18 offset1:19
    v_mfma_f32_16x16x32_bf16 a[12:15], v[128:131], v[172:175], a[12:15]
    ds_read_b128 v[228:231], v9 offset:3136
    v_mfma_f32_16x16x32_bf16 a[16:19], v[128:131], v[176:179], a[16:19]
    ds_read2_b32 v[196:197], v5 offset0:144 offset1:145
    v_mfma_f32_16x16x32_bf16 a[20:23], v[128:131], v[180:183], a[20:23]
    ds_read2_b32 v[198:199], v5 offset0:146 offset1:147
    v_mfma_f32_16x16x32_bf16 a[24:27], v[128:131], v[184:187], a[24:27]
    ds_read_b128 v[232:235], v9 offset:2624
    v_mfma_f32_16x16x32_bf16 a[28:31], v[128:131], v[188:191], a[28:31]
    ds_read2_b32 v[200:201], v6 offset0:16 offset1:17
    v_mfma_f32_16x16x32_bf16 a[4:7], v[132:135], v[160:163], a[4:7]
    ds_read2_b32 v[202:203], v6 offset0:18 offset1:19
    v_mfma_f32_16x16x32_bf16 a[8:11], v[132:135], v[164:167], a[8:11]
    ds_read_b128 v[236:239], v9 offset:2112
    v_mfma_f32_16x16x32_bf16 a[12:15], v[132:135], v[168:171], a[12:15]
    ds_read2_b32 v[204:205], v6 offset0:144 offset1:145
    v_mfma_f32_16x16x32_bf16 a[16:19], v[132:135], v[172:175], a[16:19]
    ds_read2_b32 v[206:207], v6 offset0:146 offset1:147
    v_mfma_f32_16x16x32_bf16 a[20:23], v[132:135], v[176:179], a[20:23]
    ds_read_b128 v[240:243], v9 offset:1600
    v_mfma_f32_16x16x32_bf16 a[24:27], v[132:135], v[180:183], a[24:27]
    ds_read2_b32 v[208:209], v7 offset0:16 offset1:17
    v_mfma_f32_16x16x32_bf16 a[28:31], v[132:135], v[184:187], a[28:31]
    ds_read2_b32 v[210:211], v7 offset0:18 offset1:19
    v_mfma_f32_16x16x32_bf16 a[8:11], v[136:139], v[160:163], a[8:11]
    ds_read_b128 v[244:247], v9 offset:1088
    v_mfma_f32_16x16x32_bf16 a[12:15], v[136:139], v[164:167], a[12:15]
    ds_read2_b32 v[212:213], v7 offset0:144 offset1:145
    v_mfma_f32_16x16x32_bf16 a[16:19], v[136:139], v[168:171], a[16:19]
    ds_read2_b32 v[214:215], v7 offset0:146 offset1:147
    v_mfma_f32_16x16x32_bf16 a[20:23], v[136:139], v[172:175], a[20:23]
    ds_read_b128 v[248:251], v9 offset:576
    v_mfma_f32_16x16x32_bf16 a[24:27], v[136:139], v[176:179], a[24:27]
    ds_read2_b32 v[216:217], v8 offset0:16 offset1:17
    v_mfma_f32_16x16x32_bf16 a[28:31], v[136:139], v[180:183], a[28:31]
    ds_read2_b32 v[218:219], v8 offset0:18 offset1:19
    v_mfma_f32_16x16x32_bf16 a[12:15], v[140:143], v[160:163], a[12:15]
    ds_read_b128 v[252:255], v9 offset:64
    v_mfma_f32_16x16x32_bf16 a[16:19], v[140:143], v[164:167], a[16:19]
    ds_read2_b32 v[220:221], v8 offset0:144 offset1:145
    v_mfma_f32_16x16x32_bf16 a[20:23], v[140:143], v[168:171], a[20:23]
    ds_read2_b32 v[222:223], v8 offset0:146 offset1:147
    v_mfma_f32_16x16x32_bf16 a[24:27], v[140:143], v[172:175], a[24:27]
    v_mfma_f32_16x16x32_bf16 a[28:31], v[140:143], v[176:179], a[28:31]
    v_mfma_f32_16x16x32_bf16 a[16:19], v[144:147], v[160:163], a[16:19]
    v_mfma_f32_16x16x32_bf16 a[20:23], v[144:147], v[164:167], a[20:23]
    v_mfma_f32_16x16x32_bf16 a[24:27], v[144:147], v[168:171], a[24:27]
    v_mfma_f32_16x16x32_bf16 a[28:31], v[144:147], v[172:175], a[28:31]
    v_mfma_f32_16x16x32_bf16 a[20:23], v[148:151], v[160:163], a[20:23]
    v_mfma_f32_16x16x32_bf16 a[24:27], v[148:151], v[164:167], a[24:27]
    v_mfma_f32_16x16x32_bf16 a[28:31], v[148:151], v[168:171], a[28:31]
    v_mfma_f32_16x16x32_bf16 a[24:27], v[152:155], v[160:163], a[24:27]
    v_mfma_f32_16x16x32_bf16 a[28:31], v[152:155], v[164:167], a[28:31]
    v_mfma_f32_16x16x32_bf16 a[28:31], v[156:159], v[160:163], a[28:31]
    s_waitcnt lgkmcnt(0)
    v_mfma_f32_16x16x32_bf16 a[0:3], v[192:195], v[224:227], a[0:3]
    ds_read_b128 v[160:163], v9 offset:3712
    v_mfma_f32_16x16x32_bf16 a[4:7], v[192:195], v[228:231], a[4:7]
    ds_read2_b32 v[128:129], v5 offset0:32 offset1:33
    v_mfma_f32_16x16x32_bf16 a[8:11], v[192:195], v[232:235], a[8:11]
    ds_read2_b32 v[130:131], v5 offset0:34 offset1:35
    v_mfma_f32_16x16x32_bf16 a[12:15], v[192:195], v[236:239], a[12:15]
    ds_read_b128 v[164:167], v9 offset:3200
    v_mfma_f32_16x16x32_bf16 a[16:19], v[192:195], v[240:243], a[16:19]
    ds_read2_b32 v[132:133], v5 offset0:160 offset1:161
    v_mfma_f32_16x16x32_bf16 a[20:23], v[192:195], v[244:247], a[20:23]
    ds_read2_b32 v[134:135], v5 offset0:162 offset1:163
    v_mfma_f32_16x16x32_bf16 a[24:27], v[192:195], v[248:251], a[24:27]
    ds_read_b128 v[168:171], v9 offset:2688
    v_mfma_f32_16x16x32_bf16 a[28:31], v[192:195], v[252:255], a[28:31]
    ds_read2_b32 v[136:137], v6 offset0:32 offset1:33
    v_mfma_f32_16x16x32_bf16 a[4:7], v[196:199], v[224:227], a[4:7]
    ds_read2_b32 v[138:139], v6 offset0:34 offset1:35
    v_mfma_f32_16x16x32_bf16 a[8:11], v[196:199], v[228:231], a[8:11]
    ds_read_b128 v[172:175], v9 offset:2176
    v_mfma_f32_16x16x32_bf16 a[12:15], v[196:199], v[232:235], a[12:15]
    ds_read2_b32 v[140:141], v6 offset0:160 offset1:161
    v_mfma_f32_16x16x32_bf16 a[16:19], v[196:199], v[236:239], a[16:19]
    ds_read2_b32 v[142:143], v6 offset0:162 offset1:163
    v_mfma_f32_16x16x32_bf16 a[20:23], v[196:199], v[240:243], a[20:23]
    ds_read_b128 v[176:179], v9 offset:1664
    v_mfma_f32_16x16x32_bf16 a[24:27], v[196:199], v[244:247], a[24:27]
    ds_read2_b32 v[144:145], v7 offset0:32 offset1:33
    v_mfma_f32_16x16x32_bf16 a[28:31], v[196:199], v[248:251], a[28:31]
    ds_read2_b32 v[146:147], v7 offset0:34 offset1:35
    v_mfma_f32_16x16x32_bf16 a[8:11], v[200:203], v[224:227], a[8:11]
    ds_read_b128 v[180:183], v9 offset:1152
    v_mfma_f32_16x16x32_bf16 a[12:15], v[200:203], v[228:231], a[12:15]
    ds_read2_b32 v[148:149], v7 offset0:160 offset1:161
    v_mfma_f32_16x16x32_bf16 a[16:19], v[200:203], v[232:235], a[16:19]
    ds_read2_b32 v[150:151], v7 offset0:162 offset1:163
    v_mfma_f32_16x16x32_bf16 a[20:23], v[200:203], v[236:239], a[20:23]
    ds_read_b128 v[184:187], v9 offset:640
    v_mfma_f32_16x16x32_bf16 a[24:27], v[200:203], v[240:243], a[24:27]
    ds_read2_b32 v[152:153], v8 offset0:32 offset1:33
    v_mfma_f32_16x16x32_bf16 a[28:31], v[200:203], v[244:247], a[28:31]
    ds_read2_b32 v[154:155], v8 offset0:34 offset1:35
    v_mfma_f32_16x16x32_bf16 a[12:15], v[204:207], v[224:227], a[12:15]
    ds_read_b128 v[188:191], v9 offset:128
    v_mfma_f32_16x16x32_bf16 a[16:19], v[204:207], v[228:231], a[16:19]
    ds_read2_b32 v[156:157], v8 offset0:160 offset1:161
    v_mfma_f32_16x16x32_bf16 a[20:23], v[204:207], v[232:235], a[20:23]
    ds_read2_b32 v[158:159], v8 offset0:162 offset1:163
    v_mfma_f32_16x16x32_bf16 a[24:27], v[204:207], v[236:239], a[24:27]
    v_add_u32 v5, 128, v5
    v_mfma_f32_16x16x32_bf16 a[28:31], v[204:207], v[240:243], a[28:31]
    v_add_u32 v6, 128, v6
    v_mfma_f32_16x16x32_bf16 a[16:19], v[208:211], v[224:227], a[16:19]
    v_add_u32 v7, 128, v7
    v_mfma_f32_16x16x32_bf16 a[20:23], v[208:211], v[228:231], a[20:23]
    v_add_u32 v8, 128, v8
    v_mfma_f32_16x16x32_bf16 a[24:27], v[208:211], v[232:235], a[24:27]
    v_add_u32 v9, 128, v9
    v_mfma_f32_16x16x32_bf16 a[28:31], v[208:211], v[236:239], a[28:31]
    v_mfma_f32_16x16x32_bf16 a[20:23], v[212:215], v[224:227], a[20:23]
    v_mfma_f32_16x16x32_bf16 a[24:27], v[212:215], v[228:231], a[24:27]
    v_mfma_f32_16x16x32_bf16 a[28:31], v[212:215], v[232:235], a[28:31]
    v_mfma_f32_16x16x32_bf16 a[24:27], v[216:219], v[224:227], a[24:27]
    v_mfma_f32_16x16x32_bf16 a[28:31], v[216:219], v[228:231], a[28:31]
    v_mfma_f32_16x16x32_bf16 a[28:31], v[220:223], v[224:227], a[28:31]
    s_sub_u32 s51, s51, 1
    s_cmp_lg_u32 s51, 0
    s_cbranch_scc1 L_cvl
    s_waitcnt lgkmcnt(0)
    s_waitcnt vmcnt(4)
    s_lshl_b32 s46, s20, 8
    s_add_u32 s46, s46, s2
    s_cmp_ge_u32 s46, 896
    s_cbranch_scc1 L_we
    s_mul_i32 s46, s22, 14336
    s_add_u32 s46, s46, 4194304
    s_lshl_b32 s23, s23, 3
    s_add_u32 s36, s23, 0
    s_mul_i32 s37, s36, 4682
    s_lshr_b32 s37, s37, 16
    s_mul_i32 s37, s37, 434
    s_add_u32 s36, s36, s37
    s_lshl_b32 s36, s36, 10
    s_add_u32 s36, s36, s46
    v_perm_b32 v200, v84, v80, s68
    v_perm_b32 v201, v92, v88, s68
    v_perm_b32 v202, v100, v96, s68
    v_perm_b32 v203, v108, v104, s68
    buffer_store_dwordx4 v[200:203], v3, s[32:35], s36 offen sc1
    s_add_u32 s36, s23, 1
    s_mul_i32 s37, s36, 4682
    s_lshr_b32 s37, s37, 16
    s_mul_i32 s37, s37, 434
    s_add_u32 s36, s36, s37
    s_lshl_b32 s36, s36, 10
    s_add_u32 s36, s36, s46
    v_perm_b32 v204, v84, v80, s69
    v_perm_b32 v205, v92, v88, s69
    v_perm_b32 v206, v100, v96, s69
    v_perm_b32 v207, v108, v104, s69
    buffer_store_dwordx4 v[204:207], v3, s[32:35], s36 offen sc1
    s_add_u32 s36, s23, 2
    s_mul_i32 s37, s36, 4682
    s_lshr_b32 s37, s37, 16
    s_mul_i32 s37, s37, 434
    s_add_u32 s36, s36, s37
    s_lshl_b32 s36, s36, 10
    s_add_u32 s36, s36, s46
    v_perm_b32 v208, v85, v81, s68
    v_perm_b32 v209, v93, v89, s68
    v_perm_b32 v210, v101, v97, s68
    v_perm_b32 v211, v109, v105, s68
    buffer_store_dwordx4 v[208:211], v3, s[32:35], s36 offen sc1
    s_add_u32 s36, s23, 3
    s_mul_i32 s37, s36, 4682
    s_lshr_b32 s37, s37, 16
    s_mul_i32 s37, s37, 434
    s_add_u32 s36, s36, s37
    s_lshl_b32 s36, s36, 10
    s_add_u32 s36, s36, s46
    v_perm_b32 v212, v85, v81, s69
    v_perm_b32 v213, v93, v89, s69
    v_perm_b32 v214, v101, v97, s69
    v_perm_b32 v215, v109, v105, s69
    buffer_store_dwordx4 v[212:215], v3, s[32:35], s36 offen sc1
    s_add_u32 s36, s23, 4
    s_mul_i32 s37, s36, 4682
    s_lshr_b32 s37, s37, 16
    s_mul_i32 s37, s37, 434
    s_add_u32 s36, s36, s37
    s_lshl_b32 s36, s36, 10
    s_add_u32 s36, s36, s46
    v_perm_b32 v216, v86, v82, s68
    v_perm_b32 v217, v94, v90, s68
    v_perm_b32 v218, v102, v98, s68
    v_perm_b32 v219, v110, v106, s68
    buffer_store_dwordx4 v[216:219], v3, s[32:35], s36 offen sc1
    s_add_u32 s36, s23, 5
    s_mul_i32 s37, s36, 4682
    s_lshr_b32 s37, s37, 16
    s_mul_i32 s37, s37, 434
    s_add_u32 s36, s36, s37
    s_lshl_b32 s36, s36, 10
    s_add_u32 s36, s36, s46
    v_perm_b32 v220, v86, v82, s69
    v_perm_b32 v221, v94, v90, s69
    v_perm_b32 v222, v102, v98, s69
    v_perm_b32 v223, v110, v106, s69
    buffer_store_dwordx4 v[220:223], v3, s[32:35], s36 offen sc1
    s_add_u32 s36, s23, 6
    s_mul_i32 s37, s36, 4682
    s_lshr_b32 s37, s37, 16
    s_mul_i32 s37, s37, 434
    s_add_u32 s36, s36, s37
    s_lshl_b32 s36, s36, 10
    s_add_u32 s36, s36, s46
    v_perm_b32 v224, v87, v83, s68
    v_perm_b32 v225, v95, v91, s68
    v_perm_b32 v226, v103, v99, s68
    v_perm_b32 v227, v111, v107, s68
    buffer_store_dwordx4 v[224:227], v3, s[32:35], s36 offen sc1
    s_add_u32 s36, s23, 7
    s_mul_i32 s37, s36, 4682
    s_lshr_b32 s37, s37, 16
    s_mul_i32 s37, s37, 434
    s_add_u32 s36, s36, s37
    s_lshl_b32 s36, s36, 10
    s_add_u32 s36, s36, s46
    v_perm_b32 v228, v87, v83, s69
    v_perm_b32 v229, v95, v91, s69
    v_perm_b32 v230, v103, v99, s69
    v_perm_b32 v231, v111, v107, s69
    buffer_store_dwordx4 v[228:231], v3, s[32:35], s36 offen sc1
L_we:
    v_lshlrev_b32 v4, 5, v112
    v_lshl_add_u32 v4, v113, 3, v4
    v_add_u32 v5, s48, v4
    v_sub_u32 v4, 504, v4
    v_add_u32 v4, s47, v4
    ds_read_b64 v[128:129], v4 offset:3584
    ds_read_b64 v[130:131], v4 offset:3072
    ds_read_b64 v[132:133], v4 offset:2560
    ds_read_b64 v[134:135], v4 offset:2048
    ds_read_b64 v[136:137], v4 offset:1536
    ds_read_b64 v[138:139], v4 offset:1024
    ds_read_b64 v[140:141], v4 offset:512
    ds_read_b64 v[142:143], v4 offset:0
    v_accvgpr_read_b32 v148, a0
    v_accvgpr_read_b32 v149, a1
    v_accvgpr_read_b32 v150, a2
    v_accvgpr_read_b32 v151, a3
    s_waitcnt lgkmcnt(7)
    v_and_b32 v144, 0xffff0000, v129
    v_lshlrev_b32 v145, 16, v129
    v_and_b32 v146, 0xffff0000, v128
    v_lshlrev_b32 v147, 16, v128
    v_fmac_f32 v148, s49, v144
    v_fmac_f32 v149, s49, v145
    v_fmac_f32 v150, s49, v146
    v_fmac_f32 v151, s49, v147
    v_cvt_pk_bf16_f32 v152, v148, v149
    v_cvt_pk_bf16_f32 v153, v150, v151
    ds_write_b64 v5, v[152:153] offset:0
    v_accvgpr_read_b32 v148, a4
    v_accvgpr_read_b32 v149, a5
    v_accvgpr_read_b32 v150, a6
    v_accvgpr_read_b32 v151, a7
    s_waitcnt lgkmcnt(7)
    v_and_b32 v144, 0xffff0000, v131
    v_lshlrev_b32 v145, 16, v131
    v_and_b32 v146, 0xffff0000, v130
    v_lshlrev_b32 v147, 16, v130
    v_fmac_f32 v148, s49, v144
    v_fmac_f32 v149, s49, v145
    v_fmac_f32 v150, s49, v146
    v_fmac_f32 v151, s49, v147
    v_cvt_pk_bf16_f32 v154, v148, v149
    v_cvt_pk_bf16_f32 v155, v150, v151
    ds_write_b64 v5, v[154:155] offset:512
    v_accvgpr_read_b32 v148, a8
    v_accvgpr_read_b32 v149, a9
    v_accvgpr_read_b32 v150, a10
    v_accvgpr_read_b32 v151, a11
    s_waitcnt lgkmcnt(7)
    v_and_b32 v144, 0xffff0000, v133
    v_lshlrev_b32 v145, 16, v133
    v_and_b32 v146, 0xffff0000, v132
    v_lshlrev_b32 v147, 16, v132
    v_fmac_f32 v148, s49, v144
    v_fmac_f32 v149, s49, v145
    v_fmac_f32 v150, s49, v146
    v_fmac_f32 v151, s49, v147
    v_cvt_pk_bf16_f32 v156, v148, v149
    v_cvt_pk_bf16_f32 v157, v150, v151
    ds_write_b64 v5, v[156:157] offset:1024
    v_accvgpr_read_b32 v148, a12
    v_accvgpr_read_b32 v149, a13
    v_accvgpr_read_b32 v150, a14
    v_accvgpr_read_b32 v151, a15
    s_waitcnt lgkmcnt(7)
    v_and_b32 v144, 0xffff0000, v135
    v_lshlrev_b32 v145, 16, v135
    v_and_b32 v146, 0xffff0000, v134
    v_lshlrev_b32 v147, 16, v134
    v_fmac_f32 v148, s49, v144
    v_fmac_f32 v149, s49, v145
    v_fmac_f32 v150, s49, v146
    v_fmac_f32 v151, s49, v147
    v_cvt_pk_bf16_f32 v158, v148, v149
    v_cvt_pk_bf16_f32 v159, v150, v151
    ds_write_b64 v5, v[158:159] offset:1536
    v_accvgpr_read_b32 v148, a16
    v_accvgpr_read_b32 v149, a17
    v_accvgpr_read_b32 v150, a18
    v_accvgpr_read_b32 v151, a19
    s_waitcnt lgkmcnt(7)
    v_and_b32 v144, 0xffff0000, v137
    v_lshlrev_b32 v145, 16, v137
    v_and_b32 v146, 0xffff0000, v136
    v_lshlrev_b32 v147, 16, v136
    v_fmac_f32 v148, s49, v144
    v_fmac_f32 v149, s49, v145
    v_fmac_f32 v150, s49, v146
    v_fmac_f32 v151, s49, v147
    v_cvt_pk_bf16_f32 v160, v148, v149
    v_cvt_pk_bf16_f32 v161, v150, v151
    ds_write_b64 v5, v[160:161] offset:2048
    v_accvgpr_read_b32 v148, a20
    v_accvgpr_read_b32 v149, a21
    v_accvgpr_read_b32 v150, a22
    v_accvgpr_read_b32 v151, a23
    s_waitcnt lgkmcnt(7)
    v_and_b32 v144, 0xffff0000, v139
    v_lshlrev_b32 v145, 16, v139
    v_and_b32 v146, 0xffff0000, v138
    v_lshlrev_b32 v147, 16, v138
    v_fmac_f32 v148, s49, v144
    v_fmac_f32 v149, s49, v145
    v_fmac_f32 v150, s49, v146
    v_fmac_f32 v151, s49, v147
    v_cvt_pk_bf16_f32 v162, v148, v149
    v_cvt_pk_bf16_f32 v163, v150, v151
    ds_write_b64 v5, v[162:163] offset:2560
    v_accvgpr_read_b32 v148, a24
    v_accvgpr_read_b32 v149, a25
    v_accvgpr_read_b32 v150, a26
    v_accvgpr_read_b32 v151, a27
    s_waitcnt lgkmcnt(7)
    v_and_b32 v144, 0xffff0000, v141
    v_lshlrev_b32 v145, 16, v141
    v_and_b32 v146, 0xffff0000, v140
    v_lshlrev_b32 v147, 16, v140
    v_fmac_f32 v148, s49, v144
    v_fmac_f32 v149, s49, v145
    v_fmac_f32 v150, s49, v146
    v_fmac_f32 v151, s49, v147
    v_cvt_pk_bf16_f32 v164, v148, v149
    v_cvt_pk_bf16_f32 v165, v150, v151
    ds_write_b64 v5, v[164:165] offset:3072
    v_accvgpr_read_b32 v148, a28
    v_accvgpr_read_b32 v149, a29
    v_accvgpr_read_b32 v150, a30
    v_accvgpr_read_b32 v151, a31
    s_waitcnt lgkmcnt(7)
    v_and_b32 v144, 0xffff0000, v143
    v_lshlrev_b32 v145, 16, v143
    v_and_b32 v146, 0xffff0000, v142
    v_lshlrev_b32 v147, 16, v142
    v_fmac_f32 v148, s49, v144
    v_fmac_f32 v149, s49, v145
    v_fmac_f32 v150, s49, v146
    v_fmac_f32 v151, s49, v147
    v_cvt_pk_bf16_f32 v166, v148, v149
    v_cvt_pk_bf16_f32 v167, v150, v151
    ds_write_b64 v5, v[166:167] offset:3584
    v_lshlrev_b32 v6, 2, v0
    v_add_u32 v6, 18432, v6
    s_waitcnt lgkmcnt(0)
    s_barrier
    ds_read_b32 v168, v6 offset:0
    ds_read_b32 v169, v6 offset:8320
    ds_read_b32 v170, v6 offset:16640
    ds_read_b32 v171, v6 offset:24960
    ds_read_b32 v172, v6 offset:1024
    ds_read_b32 v173, v6 offset:9344
    ds_read_b32 v174, v6 offset:17664
    ds_read_b32 v175, v6 offset:25984
    ds_read_b32 v176, v6 offset:2048
    ds_read_b32 v177, v6 offset:10368
    ds_read_b32 v178, v6 offset:18688
    ds_read_b32 v179, v6 offset:27008
    ds_read_b32 v180, v6 offset:3072
    ds_read_b32 v181, v6 offset:11392
    ds_read_b32 v182, v6 offset:19712
    ds_read_b32 v183, v6 offset:28032
    v_lshrrev_b32 v7, 2, v0
    v_lshlrev_b32 v7, 14, v7
    v_and_b32 v8, 3, v0
    v_lshl_add_u32 v7, v8, 4, v7
    s_lshl_b32 s50, s21, 4
    s_waitcnt lgkmcnt(12)
    v_perm_b32 v184, v169, v168, s68
    v_perm_b32 v185, v171, v170, s68
    v_perm_b32 v186, v169, v168, s69
    v_perm_b32 v187, v171, v170, s69
    buffer_store_dwordx4 v[184:187], v7, s[32:35], s50 offen sc1
    s_add_u32 s50, s50, 1048576
    s_waitcnt lgkmcnt(8)
    v_perm_b32 v188, v173, v172, s68
    v_perm_b32 v189, v175, v174, s68
    v_perm_b32 v190, v173, v172, s69
    v_perm_b32 v191, v175, v174, s69
    buffer_store_dwordx4 v[188:191], v7, s[32:35], s50 offen sc1
    s_add_u32 s50, s50, 1048576
    s_waitcnt lgkmcnt(4)
    v_perm_b32 v192, v177, v176, s68
    v_perm_b32 v193, v179, v178, s68
    v_perm_b32 v194, v177, v176, s69
    v_perm_b32 v195, v179, v178, s69
    buffer_store_dwordx4 v[192:195], v7, s[32:35], s50 offen sc1
    s_add_u32 s50, s50, 1048576
    s_waitcnt lgkmcnt(0)
    v_perm_b32 v196, v181, v180, s68
    v_perm_b32 v197, v183, v182, s68
    v_perm_b32 v198, v181, v180, s69
    v_perm_b32 v199, v183, v182, s69
    buffer_store_dwordx4 v[196:199], v7, s[32:35], s50 offen sc1
    s_add_u32 s50, s50, 1048576
    s_add_u32 s66, s70, s65
    s_add_u32 s66, s66, 16384
    v_mov_b32 v12, s64
    v_lshlrev_b32 v13, 10, v2
    s_waitcnt vmcnt(0)
    s_barrier
    s_cmp_lg_u32 s20, 0
    s_cbranch_scc1 L_sg1225
    s_mov_b64 exec, 0xff
    buffer_store_dword v12, v13, s[32:35], s66 offen sc1
    s_mov_b64 exec, -1
L_sg1225:
    s_cmp_eq_u32 s20, 0
    s_cbranch_scc1 L_w2le
    s_mov_b32 s28, s56
    s_and_b32 s29, s57, 0xffff
    s_mov_b32 s30, 7340032
    s_mov_b32 s31, 0x20000
    s_lshl_b32 s72, s20, 8
    s_add_u32 s72, s72, s2
    s_lshr_b32 s72, s72, 3
    s_lshr_b32 s46, s72, 2
    s_lshl_b32 s46, s46, 18
    s_and_b32 s47, s72, 3
    s_lshl_b32 s47, s47, 12
    s_add_u32 s46, s46, s47
    s_lshl_b32 s47, s58, 8
    s_add_u32 s46, s46, s47
    v_lshlrev_b32 v114, 16, v113
    v_lshl_add_u32 v114, v112, 2, v114
    s_cmp_ge_u32 s72, 112
    s_cbranch_scc1 L_w2le
    s_add_u32 s47, s46, 0
    buffer_load_dword a144, v114, s[28:31], s47 offen offset:0
    buffer_load_dword a145, v114, s[28:31], s47 offen offset:64
    buffer_load_dword a160, v114, s[28:31], s47 offen offset:128
    buffer_load_dword a161, v114, s[28:31], s47 offen offset:192
    s_add_u32 s47, s46, 16384
    buffer_load_dword a146, v114, s[28:31], s47 offen offset:0
    buffer_load_dword a147, v114, s[28:31], s47 offen offset:64
    buffer_load_dword a162, v114, s[28:31], s47 offen offset:128
    buffer_load_dword a163, v114, s[28:31], s47 offen offset:192
    s_add_u32 s47, s46, 32768
    buffer_load_dword a148, v114, s[28:31], s47 offen offset:0
    buffer_load_dword a149, v114, s[28:31], s47 offen offset:64
    buffer_load_dword a164, v114, s[28:31], s47 offen offset:128
    buffer_load_dword a165, v114, s[28:31], s47 offen offset:192
    s_add_u32 s47, s46, 49152
    buffer_load_dword a150, v114, s[28:31], s47 offen offset:0
    buffer_load_dword a151, v114, s[28:31], s47 offen offset:64
    buffer_load_dword a166, v114, s[28:31], s47 offen offset:128
    buffer_load_dword a167, v114, s[28:31], s47 offen offset:192
    s_add_u32 s47, s46, 2048
    buffer_load_dword a152, v114, s[28:31], s47 offen offset:0
    buffer_load_dword a153, v114, s[28:31], s47 offen offset:64
    buffer_load_dword a168, v114, s[28:31], s47 offen offset:128
    buffer_load_dword a169, v114, s[28:31], s47 offen offset:192
    s_add_u32 s47, s46, 18432
    buffer_load_dword a154, v114, s[28:31], s47 offen offset:0
    buffer_load_dword a155, v114, s[28:31], s47 offen offset:64
    buffer_load_dword a170, v114, s[28:31], s47 offen offset:128
    buffer_load_dword a171, v114, s[28:31], s47 offen offset:192
    s_add_u32 s47, s46, 34816
    buffer_load_dword a156, v114, s[28:31], s47 offen offset:0
    buffer_load_dword a157, v114, s[28:31], s47 offen offset:64
    buffer_load_dword a172, v114, s[28:31], s47 offen offset:128
    buffer_load_dword a173, v114, s[28:31], s47 offen offset:192
    s_add_u32 s47, s46, 51200
    buffer_load_dword a158, v114, s[28:31], s47 offen offset:0
    buffer_load_dword a159, v114, s[28:31], s47 offen offset:64
    buffer_load_dword a174, v114, s[28:31], s47 offen offset:128
    buffer_load_dword a175, v114, s[28:31], s47 offen offset:192
L_w2le:
    v_lshlrev_b32 v32, 16, v64
    v_and_b32 v33, 0xffff0000, v64
    v_lshlrev_b32 v34, 16, v65
    v_and_b32 v35, 0xffff0000, v65
    v_lshlrev_b32 v36, 16, v66
    v_and_b32 v37, 0xffff0000, v66
    v_lshlrev_b32 v38, 16, v67
    v_and_b32 v39, 0xffff0000, v67
    v_lshlrev_b32 v40, 16, v68
    v_and_b32 v41, 0xffff0000, v68
    v_lshlrev_b32 v42, 16, v69
    v_and_b32 v43, 0xffff0000, v69
    v_lshlrev_b32 v44, 16, v70
    v_and_b32 v45, 0xffff0000, v70
    v_lshlrev_b32 v46, 16, v71
    v_and_b32 v47, 0xffff0000, v71
    v_lshlrev_b32 v48, 16, v72
    v_and_b32 v49, 0xffff0000, v72
    v_lshlrev_b32 v50, 16, v73
    v_and_b32 v51, 0xffff0000, v73
    v_lshlrev_b32 v52, 16, v74
    v_and_b32 v53, 0xffff0000, v74
    v_lshlrev_b32 v54, 16, v75
    v_and_b32 v55, 0xffff0000, v75
    v_lshlrev_b32 v56, 16, v76
    v_and_b32 v57, 0xffff0000, v76
    v_lshlrev_b32 v58, 16, v77
    v_and_b32 v59, 0xffff0000, v77
    v_lshlrev_b32 v60, 16, v78
    v_and_b32 v61, 0xffff0000, v78
    v_lshlrev_b32 v62, 16, v79
    v_and_b32 v63, 0xffff0000, v79
    v_pk_add_f32 v[28:29], v[32:33], v[34:35]
    v_pk_mul_f32 v[30:31], v[32:33], v[32:33]
    v_pk_add_f32 v[16:17], v[48:49], v[50:51]
    v_pk_mul_f32 v[18:19], v[48:49], v[48:49]
    v_pk_fma_f32 v[30:31], v[34:35], v[34:35], v[30:31]
    v_pk_fma_f32 v[18:19], v[50:51], v[50:51], v[18:19]
    v_pk_add_f32 v[28:29], v[28:29], v[36:37]
    v_pk_fma_f32 v[30:31], v[36:37], v[36:37], v[30:31]
    v_pk_add_f32 v[16:17], v[16:17], v[52:53]
    v_pk_fma_f32 v[18:19], v[52:53], v[52:53], v[18:19]
    v_pk_add_f32 v[28:29], v[28:29], v[38:39]
    v_pk_fma_f32 v[30:31], v[38:39], v[38:39], v[30:31]
    v_pk_add_f32 v[16:17], v[16:17], v[54:55]
    v_pk_fma_f32 v[18:19], v[54:55], v[54:55], v[18:19]
    v_pk_add_f32 v[28:29], v[28:29], v[40:41]
    v_pk_fma_f32 v[30:31], v[40:41], v[40:41], v[30:31]
    v_pk_add_f32 v[16:17], v[16:17], v[56:57]
    v_pk_fma_f32 v[18:19], v[56:57], v[56:57], v[18:19]
    v_pk_add_f32 v[28:29], v[28:29], v[42:43]
    v_pk_fma_f32 v[30:31], v[42:43], v[42:43], v[30:31]
    v_pk_add_f32 v[16:17], v[16:17], v[58:59]
    v_pk_fma_f32 v[18:19], v[58:59], v[58:59], v[18:19]
    v_pk_add_f32 v[28:29], v[28:29], v[44:45]
    v_pk_fma_f32 v[30:31], v[44:45], v[44:45], v[30:31]
    v_pk_add_f32 v[16:17], v[16:17], v[60:61]
    v_pk_fma_f32 v[18:19], v[60:61], v[60:61], v[18:19]
    v_pk_add_f32 v[28:29], v[28:29], v[46:47]
    v_pk_fma_f32 v[30:31], v[46:47], v[46:47], v[30:31]
    v_pk_add_f32 v[16:17], v[16:17], v[62:63]
    v_pk_fma_f32 v[18:19], v[62:63], v[62:63], v[18:19]
    v_pk_add_f32 v[28:29], v[28:29], v[16:17]
    v_pk_add_f32 v[30:31], v[30:31], v[18:19]
    v_add_f32 v28, v28, v29
    v_add_f32 v29, v30, v31
    s_nop 1
    v_permlane32_swap_b32 v28, v29
    s_nop 1
    v_add_f32 v28, v28, v29
    v_mov_b32 v29, v28
    s_nop 1
    v_permlane16_swap_b32 v28, v29
    s_nop 1
    v_add_f32 v28, v28, v29
    s_nop 1
    v_add_f32_dpp v28, v28, v28 row_ror:8 row_mask:0xf bank_mask:0xf
    ds_write_b32 v25, v28 offset:0
    s_waitcnt lgkmcnt(0)
    s_barrier
    ds_read_b128 v[132:135], v24 offset:0
    ds_read_b128 v[136:139], v24 offset:16
    s_mov_b32 s54, 0x3a800000
    s_mov_b32 s55, 0x3727c5ac
    s_waitcnt lgkmcnt(0)
    v_add_f32 v132, v132, v133
    v_add_f32 v134, v134, v135
    v_add_f32 v136, v136, v137
    v_add_f32 v138, v138, v139
    v_add_f32 v132, v132, v134
    v_add_f32 v136, v136, v138
    v_mul_f32 v132, s54, v132
    v_mul_f32 v136, s54, v136
    v_fma_f32 v136, -v132, v132, v136
    v_max_f32 v136, 0, v136
    v_add_f32 v136, s55, v136
    v_rsq_f32 v136, v136
    s_nop 0
    v_mul_f32 v132, -v132, v136
    v_mov_b32 v137, v136
    v_mov_b32 v133, v132
    v_pk_fma_f32 v[176:177], v[32:33], v[136:137], v[132:133]
    v_pk_fma_f32 v[178:179], v[34:35], v[136:137], v[132:133]
    v_pk_fma_f32 v[180:181], v[36:37], v[136:137], v[132:133]
    v_pk_fma_f32 v[182:183], v[38:39], v[136:137], v[132:133]
    v_pk_fma_f32 v[184:185], v[40:41], v[136:137], v[132:133]
    v_pk_fma_f32 v[186:187], v[42:43], v[136:137], v[132:133]
    v_pk_fma_f32 v[188:189], v[44:45], v[136:137], v[132:133]
    v_pk_fma_f32 v[190:191], v[46:47], v[136:137], v[132:133]
    v_pk_fma_f32 v[192:193], v[48:49], v[136:137], v[132:133]
    v_pk_fma_f32 v[194:195], v[50:51], v[136:137], v[132:133]
    v_pk_fma_f32 v[196:197], v[52:53], v[136:137], v[132:133]
    v_pk_fma_f32 v[198:199], v[54:55], v[136:137], v[132:133]
    v_pk_fma_f32 v[200:201], v[56:57], v[136:137], v[132:133]
    v_pk_fma_f32 v[202:203], v[58:59], v[136:137], v[132:133]
    v_pk_fma_f32 v[204:205], v[60:61], v[136:137], v[132:133]
    v_pk_fma_f32 v[206:207], v[62:63], v[136:137], v[132:133]
    v_accvgpr_write_b32 a0, 0
    v_accvgpr_write_b32 a1, 0
    v_accvgpr_write_b32 a2, 0
    v_accvgpr_write_b32 a3, 0
    v_accvgpr_write_b32 a4, 0
    v_accvgpr_write_b32 a5, 0
    v_accvgpr_write_b32 a6, 0
    v_accvgpr_write_b32 a7, 0
    v_accvgpr_write_b32 a8, 0
    v_accvgpr_write_b32 a9, 0
    v_accvgpr_write_b32 a10, 0
    v_accvgpr_write_b32 a11, 0
    v_accvgpr_write_b32 a12, 0
    v_accvgpr_write_b32 a13, 0
    v_accvgpr_write_b32 a14, 0
    v_accvgpr_write_b32 a15, 0
    v_accvgpr_write_b32 a16, 0
    v_accvgpr_write_b32 a17, 0
    v_accvgpr_write_b32 a18, 0
    v_accvgpr_write_b32 a19, 0
    v_accvgpr_write_b32 a20, 0
    v_accvgpr_write_b32 a21, 0
    v_accvgpr_write_b32 a22, 0
    v_accvgpr_write_b32 a23, 0
    v_accvgpr_write_b32 a24, 0
    v_accvgpr_write_b32 a25, 0
    v_accvgpr_write_b32 a26, 0
    v_accvgpr_write_b32 a27, 0
    v_accvgpr_write_b32 a28, 0
    v_accvgpr_write_b32 a29, 0
    v_accvgpr_write_b32 a30, 0
    v_accvgpr_write_b32 a31, 0
    v_accvgpr_write_b32 a32, 0
    v_accvgpr_write_b32 a33, 0
    v_accvgpr_write_b32 a34, 0
    v_accvgpr_write_b32 a35, 0
    v_accvgpr_write_b32 a36, 0
    v_accvgpr_write_b32 a37, 0
    v_accvgpr_write_b32 a38, 0
    v_accvgpr_write_b32 a39, 0
    v_accvgpr_write_b32 a40, 0
    v_accvgpr_write_b32 a41, 0
    v_accvgpr_write_b32 a42, 0
    v_accvgpr_write_b32 a43, 0
    v_accvgpr_write_b32 a44, 0
    v_accvgpr_write_b32 a45, 0
    v_accvgpr_write_b32 a46, 0
    v_accvgpr_write_b32 a47, 0
    v_accvgpr_write_b32 a48, 0
    v_accvgpr_write_b32 a49, 0
    v_accvgpr_write_b32 a50, 0
    v_accvgpr_write_b32 a51, 0
    v_accvgpr_write_b32 a52, 0
    v_accvgpr_write_b32 a53, 0
    v_accvgpr_write_b32 a54, 0
    v_accvgpr_write_b32 a55, 0
    v_accvgpr_write_b32 a56, 0
    v_accvgpr_write_b32 a57, 0
    v_accvgpr_write_b32 a58, 0
    v_accvgpr_write_b32 a59, 0
    v_accvgpr_write_b32 a60, 0
    v_accvgpr_write_b32 a61, 0
    v_accvgpr_write_b32 a62, 0
    v_accvgpr_write_b32 a63, 0
    s_waitcnt vmcnt(32)
    s_cmp_lg_u32 s20, 0
    s_cbranch_scc1 L_wt1474d
    s_add_u32 s66, s77, s65
    s_add_u32 s66, s66, 16384
    v_and_b32 v13, 1008, v3
    s_mov_b32 s67, 0x40000
L_wt1474:
    buffer_load_dwordx4 v[8:11], v13, s[32:35], s66 offen sc1
    s_waitcnt vmcnt(0)
    v_xor_b32 v8, s64, v8
    v_xor_b32 v9, s64, v9
    v_xor_b32 v10, s64, v10
    v_xor_b32 v11, s64, v11
    v_or3_b32 v8, v8, v9, v10
    v_or_b32 v12, v8, v11
    v_cmp_ne_u32 vcc, 0, v12
    s_cmp_eq_u64 vcc, 0
    s_cbranch_scc1 L_wt1474d
    s_sub_u32 s67, s67, 1
    s_cmp_lg_u32 s67, 0
    s_cbranch_scc1 L_wt1474
L_wt1474d:
    s_barrier
    buffer_load_dwordx2 v[80:81], v15, s[32:35], s52 offen offset:0 sc1
    buffer_load_dwordx2 v[82:83], v15, s[32:35], s52 offen offset:64 sc1
    buffer_load_dwordx2 v[84:85], v15, s[32:35], s52 offen offset:1024 sc1
    buffer_load_dwordx2 v[86:87], v15, s[32:35], s52 offen offset:1088 sc1
    buffer_load_dwordx2 v[88:89], v15, s[32:35], s52 offen offset:2048 sc1
    buffer_load_dwordx2 v[90:91], v15, s[32:35], s52 offen offset:2112 sc1
    buffer_load_dwordx2 v[92:93], v15, s[32:35], s52 offen offset:3072 sc1
    buffer_load_dwordx2 v[94:95], v15, s[32:35], s52 offen offset:3136 sc1
    s_cmp_lg_u32 s20, 0
    s_cbranch_scc1 L_w2m
    s_mov_b32 s28, s56
    s_and_b32 s29, s57, 0xffff
    s_mov_b32 s30, 7340032
    s_mov_b32 s31, 0x20000
    s_lshl_b32 s72, s20, 8
    s_add_u32 s72, s72, s2
    s_lshr_b32 s72, s72, 3
    s_lshr_b32 s46, s72, 2
    s_lshl_b32 s46, s46, 18
    s_and_b32 s47, s72, 3
    s_lshl_b32 s47, s47, 12
    s_add_u32 s46, s46, s47
    s_lshl_b32 s47, s58, 8
    s_add_u32 s46, s46, s47
    v_lshlrev_b32 v114, 16, v113
    v_lshl_add_u32 v114, v112, 2, v114
    s_cmp_ge_u32 s72, 112
    s_cbranch_scc1 L_w2m
    s_add_u32 s47, s46, 0
    buffer_load_dword a144, v114, s[28:31], s47 offen offset:0
    buffer_load_dword a145, v114, s[28:31], s47 offen offset:64
    buffer_load_dword a160, v114, s[28:31], s47 offen offset:128
    buffer_load_dword a161, v114, s[28:31], s47 offen offset:192
    s_add_u32 s47, s46, 16384
    buffer_load_dword a146, v114, s[28:31], s47 offen offset:0
    buffer_load_dword a147, v114, s[28:31], s47 offen offset:64
    buffer_load_dword a162, v114, s[28:31], s47 offen offset:128
    buffer_load_dword a163, v114, s[28:31], s47 offen offset:192
    s_add_u32 s47, s46, 32768
    buffer_load_dword a148, v114, s[28:31], s47 offen offset:0
    buffer_load_dword a149, v114, s[28:31], s47 offen offset:64
    buffer_load_dword a164, v114, s[28:31], s47 offen offset:128
    buffer_load_dword a165, v114, s[28:31], s47 offen offset:192
    s_add_u32 s47, s46, 49152
    buffer_load_dword a150, v114, s[28:31], s47 offen offset:0
    buffer_load_dword a151, v114, s[28:31], s47 offen offset:64
    buffer_load_dword a166, v114, s[28:31], s47 offen offset:128
    buffer_load_dword a167, v114, s[28:31], s47 offen offset:192
    s_add_u32 s47, s46, 2048
    buffer_load_dword a152, v114, s[28:31], s47 offen offset:0
    buffer_load_dword a153, v114, s[28:31], s47 offen offset:64
    buffer_load_dword a168, v114, s[28:31], s47 offen offset:128
    buffer_load_dword a169, v114, s[28:31], s47 offen offset:192
    s_add_u32 s47, s46, 18432
    buffer_load_dword a154, v114, s[28:31], s47 offen offset:0
    buffer_load_dword a155, v114, s[28:31], s47 offen offset:64
    buffer_load_dword a170, v114, s[28:31], s47 offen offset:128
    buffer_load_dword a171, v114, s[28:31], s47 offen offset:192
    s_add_u32 s47, s46, 34816
    buffer_load_dword a156, v114, s[28:31], s47 offen offset:0
    buffer_load_dword a157, v114, s[28:31], s47 offen offset:64
    buffer_load_dword a172, v114, s[28:31], s47 offen offset:128
    buffer_load_dword a173, v114, s[28:31], s47 offen offset:192
    s_add_u32 s47, s46, 51200
    buffer_load_dword a158, v114, s[28:31], s47 offen offset:0
    buffer_load_dword a159, v114, s[28:31], s47 offen offset:64
    buffer_load_dword a174, v114, s[28:31], s47 offen offset:128
    buffer_load_dword a175, v114, s[28:31], s47 offen offset:192
    s_lshl_b32 s40, s20, 12
    s_mul_i32 s41, s20, 7168
    s_lshl_b32 s42, s16, 18
    s_add_u32 s42, s42, s40
    s_add_u32 s42, s42, s61
    s_mul_i32 s43, s17, 458752
    s_add_u32 s43, s43, s41
    s_add_u32 s43, s43, 4194304
    s_add_u32 s41, s41, 16384
    s_mov_b32 s44, 0
    s_mov_b32 s44, 0
    s_and_b32 s21, s20, 1
    s_lshr_b32 s22, s20, 1
    v_lshrrev_b32 v4, 4, v2
    v_lshlrev_b32 v4, 4, v4
    s_mul_i32 s23, s17, 896
    s_mul_i32 s24, s22, 448
    s_add_u32 s23, s23, s24
    s_add_u32 s23, s23, 79691776
    buffer_load_dwordx4 v[104:107], v4, s[32:35], s23 offen offset:0
    buffer_load_dwordx4 v[108:111], v4, s[32:35], s23 offen offset:64
    buffer_load_dwordx4 v[112:115], v4, s[32:35], s23 offen offset:128
    buffer_load_dwordx4 v[116:119], v4, s[32:35], s23 offen offset:192
    buffer_load_dwordx4 v[120:123], v4, s[32:35], s23 offen offset:256
    buffer_load_dwordx4 v[124:127], v4, s[32:35], s23 offen offset:320
    buffer_load_dwordx4 v[128:131], v4, s[32:35], s23 offen offset:384
    s_waitcnt vmcnt(39)
    s_branch L_w2n
L_w2m:
    s_lshl_b32 s40, s20, 12
    s_mul_i32 s41, s20, 7168
    s_lshl_b32 s42, s16, 18
    s_add_u32 s42, s42, s40
    s_add_u32 s42, s42, s61
    s_mul_i32 s43, s17, 458752
    s_add_u32 s43, s43, s41
    s_add_u32 s43, s43, 4194304
    s_add_u32 s41, s41, 16384
    s_mov_b32 s44, 0
    s_mov_b32 s44, 0
    s_and_b32 s21, s20, 1
    s_lshr_b32 s22, s20, 1
    v_lshrrev_b32 v4, 4, v2
    v_lshlrev_b32 v4, 4, v4
    s_mul_i32 s23, s17, 896
    s_mul_i32 s24, s22, 448
    s_add_u32 s23, s23, s24
    s_add_u32 s23, s23, 79691776
    buffer_load_dwordx4 v[104:107], v4, s[32:35], s23 offen offset:0
    buffer_load_dwordx4 v[108:111], v4, s[32:35], s23 offen offset:64
    buffer_load_dwordx4 v[112:115], v4, s[32:35], s23 offen offset:128
    buffer_load_dwordx4 v[116:119], v4, s[32:35], s23 offen offset:192
    buffer_load_dwordx4 v[120:123], v4, s[32:35], s23 offen offset:256
    buffer_load_dwordx4 v[124:127], v4, s[32:35], s23 offen offset:320
    buffer_load_dwordx4 v[128:131], v4, s[32:35], s23 offen offset:384
    s_waitcnt vmcnt(7)
L_w2n:
    v_lshlrev_b32 v208, 16, v80
    v_and_b32 v209, 0xffff0000, v80
    v_lshlrev_b32 v210, 16, v81
    v_and_b32 v211, 0xffff0000, v81
    v_lshlrev_b32 v212, 16, v82
    v_and_b32 v213, 0xffff0000, v82
    v_lshlrev_b32 v214, 16, v83
    v_and_b32 v215, 0xffff0000, v83
    v_lshlrev_b32 v216, 16, v84
    v_and_b32 v217, 0xffff0000, v84
    v_lshlrev_b32 v218, 16, v85
    v_and_b32 v219, 0xffff0000, v85
    v_lshlrev_b32 v220, 16, v86
    v_and_b32 v221, 0xffff0000, v86
    v_lshlrev_b32 v222, 16, v87
    v_and_b32 v223, 0xffff0000, v87
    v_lshlrev_b32 v224, 16, v88
    v_and_b32 v225, 0xffff0000, v88
    v_lshlrev_b32 v226, 16, v89
    v_and_b32 v227, 0xffff0000, v89
    v_lshlrev_b32 v228, 16, v90
    v_and_b32 v229, 0xffff0000, v90
    v_lshlrev_b32 v230, 16, v91
    v_and_b32 v231, 0xffff0000, v91
    v_lshlrev_b32 v232, 16, v92
    v_and_b32 v233, 0xffff0000, v92
    v_lshlrev_b32 v234, 16, v93
    v_and_b32 v235, 0xffff0000, v93
    v_lshlrev_b32 v236, 16, v94
    v_and_b32 v237, 0xffff0000, v94
    v_lshlrev_b32 v238, 16, v95
    v_and_b32 v239, 0xffff0000, v95
L_lnc:
    v_pk_fma_f32 v[32:33], v[176:177], v[208:209], v[32:33]
    v_pk_fma_f32 v[34:35], v[178:179], v[210:211], v[34:35]
    v_pk_fma_f32 v[36:37], v[180:181], v[212:213], v[36:37]
    v_pk_fma_f32 v[38:39], v[182:183], v[214:215], v[38:39]
    v_pk_fma_f32 v[40:41], v[184:185], v[216:217], v[40:41]
    v_pk_fma_f32 v[42:43], v[186:187], v[218:219], v[42:43]
    v_pk_fma_f32 v[44:45], v[188:189], v[220:221], v[44:45]
    v_pk_fma_f32 v[46:47], v[190:191], v[222:223], v[46:47]
    v_pk_fma_f32 v[48:49], v[192:193], v[224:225], v[48:49]
    v_pk_fma_f32 v[50:51], v[194:195], v[226:227], v[50:51]
    v_pk_fma_f32 v[52:53], v[196:197], v[228:229], v[52:53]
    v_pk_fma_f32 v[54:55], v[198:199], v[230:231], v[54:55]
    v_pk_fma_f32 v[56:57], v[200:201], v[232:233], v[56:57]
    v_pk_fma_f32 v[58:59], v[202:203], v[234:235], v[58:59]
    v_pk_fma_f32 v[60:61], v[204:205], v[236:237], v[60:61]
    v_pk_fma_f32 v[62:63], v[206:207], v[238:239], v[62:63]
    s_add_u32 s52, s52, s62
    v_pk_add_f32 v[28:29], v[32:33], v[34:35]
    v_pk_mul_f32 v[30:31], v[32:33], v[32:33]
    v_pk_add_f32 v[16:17], v[48:49], v[50:51]
    v_pk_mul_f32 v[18:19], v[48:49], v[48:49]
    v_pk_fma_f32 v[30:31], v[34:35], v[34:35], v[30:31]
    v_pk_fma_f32 v[18:19], v[50:51], v[50:51], v[18:19]
    v_pk_add_f32 v[28:29], v[28:29], v[36:37]
    v_pk_fma_f32 v[30:31], v[36:37], v[36:37], v[30:31]
    v_pk_add_f32 v[16:17], v[16:17], v[52:53]
    v_pk_fma_f32 v[18:19], v[52:53], v[52:53], v[18:19]
    v_pk_add_f32 v[28:29], v[28:29], v[38:39]
    v_pk_fma_f32 v[30:31], v[38:39], v[38:39], v[30:31]
    v_pk_add_f32 v[16:17], v[16:17], v[54:55]
    v_pk_fma_f32 v[18:19], v[54:55], v[54:55], v[18:19]
    v_pk_add_f32 v[28:29], v[28:29], v[40:41]
    v_pk_fma_f32 v[30:31], v[40:41], v[40:41], v[30:31]
    v_pk_add_f32 v[16:17], v[16:17], v[56:57]
    v_pk_fma_f32 v[18:19], v[56:57], v[56:57], v[18:19]
    v_pk_add_f32 v[28:29], v[28:29], v[42:43]
    v_pk_fma_f32 v[30:31], v[42:43], v[42:43], v[30:31]
    v_pk_add_f32 v[16:17], v[16:17], v[58:59]
    v_pk_fma_f32 v[18:19], v[58:59], v[58:59], v[18:19]
    v_pk_add_f32 v[28:29], v[28:29], v[44:45]
    v_pk_fma_f32 v[30:31], v[44:45], v[44:45], v[30:31]
    v_pk_add_f32 v[16:17], v[16:17], v[60:61]
    v_pk_fma_f32 v[18:19], v[60:61], v[60:61], v[18:19]
    v_pk_add_f32 v[28:29], v[28:29], v[46:47]
    v_pk_fma_f32 v[30:31], v[46:47], v[46:47], v[30:31]
    v_pk_add_f32 v[16:17], v[16:17], v[62:63]
    v_pk_fma_f32 v[18:19], v[62:63], v[62:63], v[18:19]
    v_pk_add_f32 v[28:29], v[28:29], v[16:17]
    v_pk_add_f32 v[30:31], v[30:31], v[18:19]
    v_add_f32 v28, v28, v29
    v_add_f32 v29, v30, v31
    s_nop 1
    v_permlane32_swap_b32 v28, v29
    s_nop 1
    v_add_f32 v28, v28, v29
    v_mov_b32 v29, v28
    s_nop 1
    v_permlane16_swap_b32 v28, v29
    s_nop 1
    v_add_f32 v28, v28, v29
    s_nop 1
    v_add_f32_dpp v28, v28, v28 row_ror:8 row_mask:0xf bank_mask:0xf
    ds_write_b32 v25, v28 offset:256
    s_waitcnt lgkmcnt(0)
    s_barrier
    ds_read_b128 v[132:135], v24 offset:256
    ds_read_b128 v[136:139], v24 offset:272
    s_mov_b32 s54, 0x3a800000
    s_mov_b32 s55, 0x3727c5ac
    s_waitcnt lgkmcnt(0)
    v_add_f32 v132, v132, v133
    v_add_f32 v134, v134, v135
    v_add_f32 v136, v136, v137
    v_add_f32 v138, v138, v139
    v_add_f32 v132, v132, v134
    v_add_f32 v136, v136, v138
    v_mul_f32 v132, s54, v132
    v_mul_f32 v136, s54, v136
    v_fma_f32 v136, -v132, v132, v136
    v_max_f32 v136, 0, v136
    v_add_f32 v136, s55, v136
    v_rsq_f32 v136, v136
    s_nop 0
    v_mul_f32 v132, -v132, v136
    v_mov_b32 v137, v136
    v_mov_b32 v133, v132
    v_pk_fma_f32 v[176:177], v[32:33], v[136:137], v[132:133]
    v_pk_fma_f32 v[178:179], v[34:35], v[136:137], v[132:133]
    v_pk_fma_f32 v[180:181], v[36:37], v[136:137], v[132:133]
    v_pk_fma_f32 v[182:183], v[38:39], v[136:137], v[132:133]
    v_pk_fma_f32 v[184:185], v[40:41], v[136:137], v[132:133]
    v_pk_fma_f32 v[186:187], v[42:43], v[136:137], v[132:133]
    v_pk_fma_f32 v[188:189], v[44:45], v[136:137], v[132:133]
    v_pk_fma_f32 v[190:191], v[46:47], v[136:137], v[132:133]
    v_pk_fma_f32 v[192:193], v[48:49], v[136:137], v[132:133]
    v_pk_fma_f32 v[194:195], v[50:51], v[136:137], v[132:133]
    v_pk_fma_f32 v[196:197], v[52:53], v[136:137], v[132:133]
    v_pk_fma_f32 v[198:199], v[54:55], v[136:137], v[132:133]
    v_pk_fma_f32 v[200:201], v[56:57], v[136:137], v[132:133]
    v_pk_fma_f32 v[202:203], v[58:59], v[136:137], v[132:133]
    v_pk_fma_f32 v[204:205], v[60:61], v[136:137], v[132:133]
    v_pk_fma_f32 v[206:207], v[62:63], v[136:137], v[132:133]
    v_cvt_pk_bf16_f32 v176, v176, v177
    v_cvt_pk_bf16_f32 v177, v178, v179
    v_cvt_pk_bf16_f32 v178, v180, v181
    v_cvt_pk_bf16_f32 v179, v182, v183
    buffer_store_dwordx4 v[176:179], v26, s[32:35], s53 offen sc1
    s_add_u32 s53, s53, 16384
    v_cvt_pk_bf16_f32 v184, v184, v185
    v_cvt_pk_bf16_f32 v185, v186, v187
    v_cvt_pk_bf16_f32 v186, v188, v189
    v_cvt_pk_bf16_f32 v187, v190, v191
    buffer_store_dwordx4 v[184:187], v26, s[32:35], s53 offen sc1
    s_add_u32 s53, s53, 16384
    v_cvt_pk_bf16_f32 v192, v192, v193
    v_cvt_pk_bf16_f32 v193, v194, v195
    v_cvt_pk_bf16_f32 v194, v196, v197
    v_cvt_pk_bf16_f32 v195, v198, v199
    buffer_store_dwordx4 v[192:195], v26, s[32:35], s53 offen sc1
    s_add_u32 s53, s53, 16384
    v_cvt_pk_bf16_f32 v200, v200, v201
    v_cvt_pk_bf16_f32 v201, v202, v203
    v_cvt_pk_bf16_f32 v202, v204, v205
    v_cvt_pk_bf16_f32 v203, v206, v207
    buffer_store_dwordx4 v[200:203], v26, s[32:35], s53 offen sc1
    s_add_u32 s53, s53, 16384
    s_add_u32 s66, s78, s65
    s_add_u32 s66, s66, 32768
    v_mov_b32 v12, s64
    v_lshlrev_b32 v13, 10, v2
    s_waitcnt vmcnt(0)
    s_barrier
    s_cmp_lg_u32 s20, 0
    s_cbranch_scc1 L_sg1787
    s_mov_b64 exec, 1
    buffer_store_dword v12, v13, s[32:35], s66 offen sc1
    s_mov_b64 exec, -1
L_sg1787:
    s_add_u32 s43, s43, 86016
    s_cmp_eq_u32 s20, 0
    s_cbranch_scc1 L_gw
    s_sub_u32 s46, s20, 1
    s_mul_i32 s47, s46, 28672
    s_mul_i32 s48, s17, 458752
    s_add_u32 s47, s47, s48
    s_add_u32 s47, s47, 4194304
    s_mul_i32 s46, s46, 45056
    s_add_u32 m0, s46, 16384
    s_add_u32 s48, s47, 0
    buffer_load_dwordx4 v3, s[32:35], s48 offen offset:0 lds
    buffer_load_dwordx4 v3, s[32:35], s48 offen offset:1024 lds
    buffer_load_dwordx4 v3, s[32:35], s48 offen offset:2048 lds
    buffer_load_dwordx4 v3, s[32:35], s48 offen offset:3072 lds
    s_add_u32 m0, s46, 20480
    s_add_u32 s48, s47, 4096
    buffer_load_dwordx4 v3, s[32:35], s48 offen offset:0 lds
    buffer_load_dwordx4 v3, s[32:35], s48 offen offset:1024 lds
    buffer_load_dwordx4 v3, s[32:35], s48 offen offset:2048 lds
    buffer_load_dwordx4 v3, s[32:35], s48 offen offset:3072 lds
    s_add_u32 m0, s46, 24576
    s_add_u32 s48, s47, 8192
    buffer_load_dwordx4 v3, s[32:35], s48 offen offset:0 lds
    buffer_load_dwordx4 v3, s[32:35], s48 offen offset:1024 lds
    buffer_load_dwordx4 v3, s[32:35], s48 offen offset:2048 lds
    buffer_load_dwordx4 v3, s[32:35], s48 offen offset:3072 lds
    s_add_u32 m0, s46, 28672
    s_add_u32 s48, s47, 12288
    buffer_load_dwordx4 v3, s[32:35], s48 offen offset:0 lds
    buffer_load_dwordx4 v3, s[32:35], s48 offen offset:1024 lds
    buffer_load_dwordx4 v3, s[32:35], s48 offen offset:2048 lds
    buffer_load_dwordx4 v3, s[32:35], s48 offen offset:3072 lds
    s_add_u32 m0, s46, 32768
    s_add_u32 s48, s47, 16384
    buffer_load_dwordx4 v3, s[32:35], s48 offen offset:0 lds
    buffer_load_dwordx4 v3, s[32:35], s48 offen offset:1024 lds
    buffer_load_dwordx4 v3, s[32:35], s48 offen offset:2048 lds
    buffer_load_dwordx4 v3, s[32:35], s48 offen offset:3072 lds
    s_add_u32 m0, s46, 36864
    s_add_u32 s48, s47, 20480
    buffer_load_dwordx4 v3, s[32:35], s48 offen offset:0 lds
    buffer_load_dwordx4 v3, s[32:35], s48 offen offset:1024 lds
    buffer_load_dwordx4 v3, s[32:35], s48 offen offset:2048 lds
    buffer_load_dwordx4 v3, s[32:35], s48 offen offset:3072 lds
    s_add_u32 m0, s46, 40960
    s_add_u32 s48, s47, 24576
    buffer_load_dwordx4 v3, s[32:35], s48 offen offset:0 lds
    buffer_load_dwordx4 v3, s[32:35], s48 offen offset:1024 lds
    buffer_load_dwordx4 v3, s[32:35], s48 offen offset:2048 lds
    buffer_load_dwordx4 v3, s[32:35], s48 offen offset:3072 lds
L_gw:
    v_cvt_pk_bf16_f32 v64, v32, v33
    v_accvgpr_write_b32 a128, v80
    v_cvt_pk_bf16_f32 v65, v34, v35
    v_accvgpr_write_b32 a129, v81
    v_cvt_pk_bf16_f32 v66, v36, v37
    v_accvgpr_write_b32 a130, v82
    v_cvt_pk_bf16_f32 v67, v38, v39
    v_accvgpr_write_b32 a131, v83
    v_cvt_pk_bf16_f32 v68, v40, v41
    v_accvgpr_write_b32 a132, v84
    v_cvt_pk_bf16_f32 v69, v42, v43
    v_accvgpr_write_b32 a133, v85
    v_cvt_pk_bf16_f32 v70, v44, v45
    v_accvgpr_write_b32 a134, v86
    v_cvt_pk_bf16_f32 v71, v46, v47
    v_accvgpr_write_b32 a135, v87
    v_cvt_pk_bf16_f32 v72, v48, v49
    v_accvgpr_write_b32 a136, v88
    v_cvt_pk_bf16_f32 v73, v50, v51
    v_accvgpr_write_b32 a137, v89
    v_cvt_pk_bf16_f32 v74, v52, v53
    v_accvgpr_write_b32 a138, v90
    v_cvt_pk_bf16_f32 v75, v54, v55
    v_accvgpr_write_b32 a139, v91
    v_cvt_pk_bf16_f32 v76, v56, v57
    v_accvgpr_write_b32 a140, v92
    v_cvt_pk_bf16_f32 v77, v58, v59
    v_accvgpr_write_b32 a141, v93
    v_cvt_pk_bf16_f32 v78, v60, v61
    v_accvgpr_write_b32 a142, v94
    v_cvt_pk_bf16_f32 v79, v62, v63
    v_accvgpr_write_b32 a143, v95
    v_accvgpr_write_b32 a240, v64
    v_accvgpr_write_b32 a241, v65
    v_accvgpr_write_b32 a242, v66
    v_accvgpr_write_b32 a243, v67
    v_accvgpr_write_b32 a244, v68
    v_accvgpr_write_b32 a245, v69
    v_accvgpr_write_b32 a246, v70
    v_accvgpr_write_b32 a247, v71
    v_accvgpr_write_b32 a248, v72
    v_accvgpr_write_b32 a249, v73
    v_accvgpr_write_b32 a250, v74
    v_accvgpr_write_b32 a251, v75
    v_accvgpr_write_b32 a252, v76
    v_accvgpr_write_b32 a253, v77
    v_accvgpr_write_b32 a254, v78
    v_accvgpr_write_b32 a255, v79
    v_pk_mov_b32 v[132:133], v[104:105], v[104:105] op_sel:[0,1]
    v_pk_mov_b32 v[134:135], v[106:107], v[106:107] op_sel:[0,1]
    v_pk_mov_b32 v[136:137], v[104:105], v[104:105] op_sel:[0,1]
    v_pk_mov_b32 v[138:139], v[106:107], v[106:107] op_sel:[0,1]
    v_pk_mov_b32 v[140:141], v[104:105], v[104:105] op_sel:[0,1]
    v_pk_mov_b32 v[142:143], v[106:107], v[106:107] op_sel:[0,1]
    v_pk_mov_b32 v[144:145], v[104:105], v[104:105] op_sel:[0,1]
    v_pk_mov_b32 v[146:147], v[106:107], v[106:107] op_sel:[0,1]
    v_pk_mov_b32 v[148:149], v[108:109], v[108:109] op_sel:[0,1]
    v_pk_mov_b32 v[150:151], v[110:111], v[110:111] op_sel:[0,1]
    v_pk_mov_b32 v[152:153], v[108:109], v[108:109] op_sel:[0,1]
    v_pk_mov_b32 v[154:155], v[110:111], v[110:111] op_sel:[0,1]
    v_pk_mov_b32 v[156:157], v[108:109], v[108:109] op_sel:[0,1]
    v_pk_mov_b32 v[158:159], v[110:111], v[110:111] op_sel:[0,1]
    v_pk_mov_b32 v[160:161], v[108:109], v[108:109] op_sel:[0,1]
    v_pk_mov_b32 v[162:163], v[110:111], v[110:111] op_sel:[0,1]
    v_pk_mov_b32 v[164:165], v[112:113], v[112:113] op_sel:[0,1]
    v_pk_mov_b32 v[166:167], v[114:115], v[114:115] op_sel:[0,1]
    v_pk_mov_b32 v[168:169], v[112:113], v[112:113] op_sel:[0,1]
    v_pk_mov_b32 v[170:171], v[114:115], v[114:115] op_sel:[0,1]
    v_pk_mov_b32 v[172:173], v[112:113], v[112:113] op_sel:[0,1]
    v_pk_mov_b32 v[174:175], v[114:115], v[114:115] op_sel:[0,1]
    v_pk_mov_b32 v[176:177], v[112:113], v[112:113] op_sel:[0,1]
    v_pk_mov_b32 v[178:179], v[114:115], v[114:115] op_sel:[0,1]
    v_pk_mov_b32 v[180:181], v[116:117], v[116:117] op_sel:[0,1]
    v_pk_mov_b32 v[182:183], v[118:119], v[118:119] op_sel:[0,1]
    v_pk_mov_b32 v[184:185], v[116:117], v[116:117] op_sel:[0,1]
    v_pk_mov_b32 v[186:187], v[118:119], v[118:119] op_sel:[0,1]
    v_pk_mov_b32 v[188:189], v[116:117], v[116:117] op_sel:[0,1]
    v_pk_mov_b32 v[190:191], v[118:119], v[118:119] op_sel:[0,1]
    v_pk_mov_b32 v[192:193], v[116:117], v[116:117] op_sel:[0,1]
    v_pk_mov_b32 v[194:195], v[118:119], v[118:119] op_sel:[0,1]
    v_pk_mov_b32 v[196:197], v[120:121], v[120:121] op_sel:[0,1]
    v_pk_mov_b32 v[198:199], v[122:123], v[122:123] op_sel:[0,1]
    v_pk_mov_b32 v[200:201], v[120:121], v[120:121] op_sel:[0,1]
    v_pk_mov_b32 v[202:203], v[122:123], v[122:123] op_sel:[0,1]
    v_pk_mov_b32 v[204:205], v[120:121], v[120:121] op_sel:[0,1]
    v_pk_mov_b32 v[206:207], v[122:123], v[122:123] op_sel:[0,1]
    v_pk_mov_b32 v[208:209], v[120:121], v[120:121] op_sel:[0,1]
    v_pk_mov_b32 v[210:211], v[122:123], v[122:123] op_sel:[0,1]
    v_pk_mov_b32 v[212:213], v[124:125], v[124:125] op_sel:[0,1]
    v_pk_mov_b32 v[214:215], v[126:127], v[126:127] op_sel:[0,1]
    v_pk_mov_b32 v[216:217], v[124:125], v[124:125] op_sel:[0,1]
    v_pk_mov_b32 v[218:219], v[126:127], v[126:127] op_sel:[0,1]
    v_pk_mov_b32 v[220:221], v[124:125], v[124:125] op_sel:[0,1]
    v_pk_mov_b32 v[222:223], v[126:127], v[126:127] op_sel:[0,1]
    v_pk_mov_b32 v[224:225], v[124:125], v[124:125] op_sel:[0,1]
    v_pk_mov_b32 v[226:227], v[126:127], v[126:127] op_sel:[0,1]
    v_pk_mov_b32 v[228:229], v[128:129], v[128:129] op_sel:[0,1]
    v_pk_mov_b32 v[230:231], v[130:131], v[130:131] op_sel:[0,1]
    v_pk_mov_b32 v[232:233], v[128:129], v[128:129] op_sel:[0,1]
    v_pk_mov_b32 v[234:235], v[130:131], v[130:131] op_sel:[0,1]
    v_pk_mov_b32 v[236:237], v[128:129], v[128:129] op_sel:[0,1]
    v_pk_mov_b32 v[238:239], v[130:131], v[130:131] op_sel:[0,1]
    v_pk_mov_b32 v[240:241], v[128:129], v[128:129] op_sel:[0,1]
    v_pk_mov_b32 v[242:243], v[130:131], v[130:131] op_sel:[0,1]
    s_cmp_lg_u32 s20, 0
    s_cbranch_scc1 L_wt1949d
    s_add_u32 s66, s79, s65
    s_add_u32 s66, s66, 32768
    v_and_b32 v13, 48, v3
    s_mov_b32 s67, 0x40000
L_wt1949:
    buffer_load_dwordx4 v[8:11], v13, s[32:35], s66 offen sc1
    s_waitcnt vmcnt(0)
    v_xor_b32 v8, s64, v8
    v_xor_b32 v9, s64, v9
    v_xor_b32 v10, s64, v10
    v_xor_b32 v11, s64, v11
    v_or3_b32 v8, v8, v9, v10
    v_or_b32 v12, v8, v11
    v_cmp_ne_u32 vcc, 0, v12
    s_cmp_eq_u64 vcc, 0
    s_cbranch_scc1 L_wt1949d
    s_sub_u32 s67, s67, 1
    s_cmp_lg_u32 s67, 0
    s_cbranch_scc1 L_wt1949
L_wt1949d:
    s_barrier
    s_add_u32 m0, s40, s44
    s_add_u32 s44, s44, 45056
    buffer_load_dwordx4 v3, s[32:35], s42 offen lds
    buffer_load_dwordx4 v3, s[32:35], s42 offen offset:1024 lds
    buffer_load_dwordx4 v3, s[32:35], s42 offen offset:2048 lds
    buffer_load_dwordx4 v3, s[32:35], s42 offen offset:3072 lds
    s_add_u32 s42, s42, 16384
    s_cmp_eq_u32 s44, 135168
    s_cselect_b32 s44, 0, s44
    s_add_u32 m0, s40, s44
    s_add_u32 s44, s44, 45056
    buffer_load_dwordx4 v3, s[32:35], s42 offen lds
    buffer_load_dwordx4 v3, s[32:35], s42 offen offset:1024 lds
    buffer_load_dwordx4 v3, s[32:35], s42 offen offset:2048 lds
    buffer_load_dwordx4 v3, s[32:35], s42 offen offset:3072 lds
    s_add_u32 s42, s42, 16384
    s_cmp_eq_u32 s44, 135168
    s_cselect_b32 s44, 0, s44
    s_add_u32 m0, s40, s44
    s_add_u32 s44, s44, 45056
    buffer_load_dwordx4 v3, s[32:35], s42 offen lds
    buffer_load_dwordx4 v3, s[32:35], s42 offen offset:1024 lds
    buffer_load_dwordx4 v3, s[32:35], s42 offen offset:2048 lds
    buffer_load_dwordx4 v3, s[32:35], s42 offen offset:3072 lds
    s_add_u32 s42, s42, 16384
    s_cmp_eq_u32 s44, 135168
    s_cselect_b32 s44, 0, s44
    s_lshl_b32 s24, s21, 12
    s_mul_i32 s25, s22, 7168
    s_add_u32 s25, s25, 16384
    v_add_u32 v5, s24, v3
    v_add_u32 v8, s25, v3
    v_mov_b32 v6, v5
    v_mov_b32 v9, v8
    s_mov_b32 s36, 0
    s_mul_i32 s26, s16, 917504
    s_mul_i32 s27, s17, 57344
    s_add_u32 s26, s26, s27
    s_lshl_b32 s27, s21, 12
    s_add_u32 s26, s26, s27
    s_add_u32 s26, s26, s63
    s_cmp_ge_u32 s72, 112
    s_cbranch_scc1 L_w2se
    v_accvgpr_read_b32 v16, a144
    v_accvgpr_read_b32 v17, a145
    v_accvgpr_read_b32 v18, a146
    v_accvgpr_read_b32 v19, a147
    v_accvgpr_read_b32 v20, a148
    v_accvgpr_read_b32 v21, a149
    v_accvgpr_read_b32 v22, a150
    v_accvgpr_read_b32 v23, a151
    v_accvgpr_read_b32 v24, a152
    v_accvgpr_read_b32 v25, a153
    v_accvgpr_read_b32 v26, a154
    v_accvgpr_read_b32 v27, a155
    v_accvgpr_read_b32 v28, a156
    v_accvgpr_read_b32 v29, a157
    v_accvgpr_read_b32 v30, a158
    v_accvgpr_read_b32 v31, a159
    v_accvgpr_read_b32 v32, a160
    v_accvgpr_read_b32 v33, a161
    v_accvgpr_read_b32 v34, a162
    v_accvgpr_read_b32 v35, a163
    v_accvgpr_read_b32 v36, a164
    v_accvgpr_read_b32 v37, a165
    v_accvgpr_read_b32 v38, a166
    v_accvgpr_read_b32 v39, a167
    v_accvgpr_read_b32 v40, a168
    v_accvgpr_read_b32 v41, a169
    v_accvgpr_read_b32 v42, a170
    v_accvgpr_read_b32 v43, a171
    v_accvgpr_read_b32 v44, a172
    v_accvgpr_read_b32 v45, a173
    v_accvgpr_read_b32 v46, a174
    v_accvgpr_read_b32 v47, a175
    s_mul_i32 s46, s58, 917504
    s_lshl_b32 s47, s72, 12
    s_add_u32 s46, s46, s47
    s_add_u32 s46, s46, 12582912
    s_mov_b32 s72, 112
    v_perm_b32 v48, v18, v16, s68
    v_perm_b32 v49, v22, v20, s68
    v_perm_b32 v50, v26, v24, s68
    v_perm_b32 v51, v30, v28, s68
    buffer_store_dwordx4 v[48:51], v3, s[32:35], s46 offen offset:0 sc1
    v_perm_b32 v52, v18, v16, s69
    v_perm_b32 v53, v22, v20, s69
    v_perm_b32 v54, v26, v24, s69
    v_perm_b32 v55, v30, v28, s69
    buffer_store_dwordx4 v[52:55], v3, s[32:35], s46 offen offset:1024 sc1
    v_perm_b32 v56, v19, v17, s68
    v_perm_b32 v57, v23, v21, s68
    v_perm_b32 v58, v27, v25, s68
    v_perm_b32 v59, v31, v29, s68
    buffer_store_dwordx4 v[56:59], v3, s[32:35], s46 offen offset:2048 sc1
    v_perm_b32 v60, v19, v17, s69
    v_perm_b32 v61, v23, v21, s69
    v_perm_b32 v62, v27, v25, s69
    v_perm_b32 v63, v31, v29, s69
    buffer_store_dwordx4 v[60:63], v3, s[32:35], s46 offen offset:3072 sc1
    s_add_u32 s46, s46, 458752
    v_perm_b32 v64, v34, v32, s68
    v_perm_b32 v65, v38, v36, s68
    v_perm_b32 v66, v42, v40, s68
    v_perm_b32 v67, v46, v44, s68
    buffer_store_dwordx4 v[64:67], v3, s[32:35], s46 offen offset:0 sc1
    v_perm_b32 v68, v34, v32, s69
    v_perm_b32 v69, v38, v36, s69
    v_perm_b32 v70, v42, v40, s69
    v_perm_b32 v71, v46, v44, s69
    buffer_store_dwordx4 v[68:71], v3, s[32:35], s46 offen offset:1024 sc1
    v_perm_b32 v72, v35, v33, s68
    v_perm_b32 v73, v39, v37, s68
    v_perm_b32 v74, v43, v41, s68
    v_perm_b32 v75, v47, v45, s68
    buffer_store_dwordx4 v[72:75], v3, s[32:35], s46 offen offset:2048 sc1
    v_perm_b32 v76, v35, v33, s69
    v_perm_b32 v77, v39, v37, s69
    v_perm_b32 v78, v43, v41, s69
    v_perm_b32 v79, v47, v45, s69
    buffer_store_dwordx4 v[76:79], v3, s[32:35], s46 offen offset:3072 sc1
    s_add_u32 s46, s46, 458752
    s_waitcnt vmcnt(12)
    s_branch L_w2sf
L_w2se:
    s_cmp_eq_u32 s60, 0
    s_cbranch_scc1 L_x1k
    buffer_store_dwordx4 v[64:67], v14, s[32:35], s52 offen offset:0 sc1
    buffer_store_dwordx4 v[68:71], v14, s[32:35], s52 offen offset:128 sc1
    buffer_store_dwordx4 v[72:75], v14, s[32:35], s52 offen offset:256 sc1
    buffer_store_dwordx4 v[76:79], v14, s[32:35], s52 offen offset:384 sc1
    s_waitcnt vmcnt(8)
    s_branch L_w2sf
L_x1k:
    s_waitcnt vmcnt(4)
L_w2sf:
    s_barrier
    ds_read_b128 v[32:35], v9 offset:0
    ds_read_b128 v[16:19], v6 offset:0
    ds_read_b128 v[20:23], v6 offset:1024
    ds_read_b128 v[24:27], v6 offset:2048
    ds_read_b128 v[28:31], v6 offset:3072
    ds_read_b128 v[36:39], v9 offset:1024
    ds_read_b128 v[40:43], v9 offset:2048
    ds_read_b128 v[44:47], v9 offset:3072
    ds_read_b128 v[48:51], v9 offset:4096
    ds_read_b128 v[52:55], v9 offset:5120
    ds_read_b128 v[56:59], v9 offset:6144
    s_lshl_b32 s27, s21, 12
    s_sub_u32 s38, s26, s27
    s_mul_i32 s27, s20, 14336
    s_add_u32 s38, s38, s27
    s_mov_b32 s37, 13
L_cl_g1:
    s_waitcnt lgkmcnt(0)
    v_mfma_f32_16x16x32_bf16 v[132:135], v[32:35], v[16:19], v[132:135]
    ds_read_b128 v[76:79], v9 offset:14336
    v_mfma_f32_16x16x32_bf16 v[136:139], v[32:35], v[20:23], v[136:139]
    ds_read_b128 v[60:63], v6 offset:8192
    v_mfma_f32_16x16x32_bf16 v[140:143], v[32:35], v[24:27], v[140:143]
    ds_read_b128 v[64:67], v6 offset:9216
    v_mfma_f32_16x16x32_bf16 v[144:147], v[32:35], v[28:31], v[144:147]
    ds_read_b128 v[68:71], v6 offset:10240
    v_mfma_f32_16x16x32_bf16 v[148:151], v[36:39], v[16:19], v[148:151]
    ds_read_b128 v[72:75], v6 offset:11264
    v_mfma_f32_16x16x32_bf16 v[152:155], v[36:39], v[20:23], v[152:155]
    ds_read_b128 v[80:83], v9 offset:15360
    v_mfma_f32_16x16x32_bf16 v[156:159], v[36:39], v[24:27], v[156:159]
    ds_read_b128 v[84:87], v9 offset:16384
    v_mfma_f32_16x16x32_bf16 v[160:163], v[36:39], v[28:31], v[160:163]
    ds_read_b128 v[88:91], v9 offset:17408
    v_mfma_f32_16x16x32_bf16 v[164:167], v[40:43], v[16:19], v[164:167]
    ds_read_b128 v[92:95], v9 offset:18432
    v_mfma_f32_16x16x32_bf16 v[168:171], v[40:43], v[20:23], v[168:171]
    ds_read_b128 v[96:99], v9 offset:19456
    v_mfma_f32_16x16x32_bf16 v[172:175], v[40:43], v[24:27], v[172:175]
    ds_read_b128 v[100:103], v9 offset:20480
    v_mfma_f32_16x16x32_bf16 v[176:179], v[40:43], v[28:31], v[176:179]
    s_add_u32 s36, s36, 45056
    s_cmp_eq_u32 s36, 135168
    s_cselect_b32 s36, 0, s36
    v_mfma_f32_16x16x32_bf16 v[180:183], v[44:47], v[16:19], v[180:183]
    v_add_u32 v6, s36, v5
    v_mfma_f32_16x16x32_bf16 v[184:187], v[44:47], v[20:23], v[184:187]
    v_add_u32 v9, s36, v8
    v_mfma_f32_16x16x32_bf16 v[188:191], v[44:47], v[24:27], v[188:191]
    v_mfma_f32_16x16x32_bf16 v[192:195], v[44:47], v[28:31], v[192:195]
    v_mfma_f32_16x16x32_bf16 v[196:199], v[48:51], v[16:19], v[196:199]
    v_mfma_f32_16x16x32_bf16 v[200:203], v[48:51], v[20:23], v[200:203]
    s_waitcnt vmcnt(11) lgkmcnt(0)
    s_barrier
    v_mfma_f32_16x16x32_bf16 v[204:207], v[48:51], v[24:27], v[204:207]
    v_mfma_f32_16x16x32_bf16 v[208:211], v[48:51], v[28:31], v[208:211]
    s_add_u32 m0, s41, s44
    s_add_u32 s45, s43, 4096
    buffer_load_dwordx4 v3, s[32:35], s43 offen lds
    v_mfma_f32_16x16x32_bf16 v[212:215], v[52:55], v[16:19], v[212:215]
    v_mfma_f32_16x16x32_bf16 v[216:219], v[52:55], v[20:23], v[216:219]
    buffer_load_dwordx4 v3, s[32:35], s43 offen offset:1024 lds
    v_mfma_f32_16x16x32_bf16 v[220:223], v[52:55], v[24:27], v[220:223]
    v_mfma_f32_16x16x32_bf16 v[224:227], v[52:55], v[28:31], v[224:227]
    buffer_load_dwordx4 v3, s[32:35], s43 offen offset:2048 lds
    v_mfma_f32_16x16x32_bf16 v[228:231], v[56:59], v[16:19], v[228:231]
    v_mfma_f32_16x16x32_bf16 v[232:235], v[56:59], v[20:23], v[232:235]
    buffer_load_dwordx4 v3, s[32:35], s43 offen offset:3072 lds
    v_mfma_f32_16x16x32_bf16 v[236:239], v[56:59], v[24:27], v[236:239]
    v_mfma_f32_16x16x32_bf16 v[240:243], v[56:59], v[28:31], v[240:243]
    v_mfma_f32_16x16x32_bf16 v[132:135], v[76:79], v[60:63], v[132:135]
    ds_read_b128 v[32:35], v9 offset:0
    v_mfma_f32_16x16x32_bf16 v[136:139], v[76:79], v[64:67], v[136:139]
    ds_read_b128 v[16:19], v6 offset:0
    v_mfma_f32_16x16x32_bf16 v[140:143], v[76:79], v[68:71], v[140:143]
    ds_read_b128 v[20:23], v6 offset:1024
    v_mfma_f32_16x16x32_bf16 v[144:147], v[76:79], v[72:75], v[144:147]
    ds_read_b128 v[24:27], v6 offset:2048
    v_mfma_f32_16x16x32_bf16 v[148:151], v[80:83], v[60:63], v[148:151]
    ds_read_b128 v[28:31], v6 offset:3072
    v_mfma_f32_16x16x32_bf16 v[152:155], v[80:83], v[64:67], v[152:155]
    ds_read_b128 v[36:39], v9 offset:1024
    v_mfma_f32_16x16x32_bf16 v[156:159], v[80:83], v[68:71], v[156:159]
    ds_read_b128 v[40:43], v9 offset:2048
    v_mfma_f32_16x16x32_bf16 v[160:163], v[80:83], v[72:75], v[160:163]
    ds_read_b128 v[44:47], v9 offset:3072
    v_mfma_f32_16x16x32_bf16 v[164:167], v[84:87], v[60:63], v[164:167]
    ds_read_b128 v[48:51], v9 offset:4096
    v_mfma_f32_16x16x32_bf16 v[168:171], v[84:87], v[64:67], v[168:171]
    ds_read_b128 v[52:55], v9 offset:5120
    v_mfma_f32_16x16x32_bf16 v[172:175], v[84:87], v[68:71], v[172:175]
    ds_read_b128 v[56:59], v9 offset:6144
    v_mfma_f32_16x16x32_bf16 v[176:179], v[84:87], v[72:75], v[176:179]
    v_mfma_f32_16x16x32_bf16 v[180:183], v[88:91], v[60:63], v[180:183]
    s_add_u32 m0, m0, 4096
    s_add_u32 s43, s43, 28672
    buffer_load_dwordx4 v3, s[32:35], s45 offen lds
    v_mfma_f32_16x16x32_bf16 v[184:187], v[88:91], v[64:67], v[184:187]
    v_mfma_f32_16x16x32_bf16 v[188:191], v[88:91], v[68:71], v[188:191]
    buffer_load_dwordx4 v3, s[32:35], s45 offen offset:1024 lds
    v_mfma_f32_16x16x32_bf16 v[192:195], v[88:91], v[72:75], v[192:195]
    v_mfma_f32_16x16x32_bf16 v[196:199], v[92:95], v[60:63], v[196:199]
    buffer_load_dwordx4 v3, s[32:35], s45 offen offset:2048 lds
    v_mfma_f32_16x16x32_bf16 v[200:203], v[92:95], v[64:67], v[200:203]
    v_mfma_f32_16x16x32_bf16 v[204:207], v[92:95], v[68:71], v[204:207]
    s_add_u32 m0, s40, s44
    s_add_u32 s44, s44, 45056
    buffer_load_dwordx4 v3, s[32:35], s42 offen lds
    v_mfma_f32_16x16x32_bf16 v[208:211], v[92:95], v[72:75], v[208:211]
    v_mfma_f32_16x16x32_bf16 v[212:215], v[96:99], v[60:63], v[212:215]
    buffer_load_dwordx4 v3, s[32:35], s42 offen offset:1024 lds
    v_mfma_f32_16x16x32_bf16 v[216:219], v[96:99], v[64:67], v[216:219]
    v_mfma_f32_16x16x32_bf16 v[220:223], v[96:99], v[68:71], v[220:223]
    buffer_load_dwordx4 v3, s[32:35], s42 offen offset:2048 lds
    v_mfma_f32_16x16x32_bf16 v[224:227], v[96:99], v[72:75], v[224:227]
    v_mfma_f32_16x16x32_bf16 v[228:231], v[100:103], v[60:63], v[228:231]
    buffer_load_dwordx4 v3, s[32:35], s42 offen offset:3072 lds
    s_add_u32 s42, s42, 16384
    s_cmp_eq_u32 s44, 135168
    s_cselect_b32 s44, 0, s44
    v_mfma_f32_16x16x32_bf16 v[232:235], v[100:103], v[64:67], v[232:235]
    v_mfma_f32_16x16x32_bf16 v[236:239], v[100:103], v[68:71], v[236:239]
    s_sub_u32 s37, s37, 1
    s_cmp_lg_u32 s37, 0
    v_mfma_f32_16x16x32_bf16 v[240:243], v[100:103], v[72:75], v[240:243]
    s_cbranch_scc1 L_cl_g1
    s_or_b32 s66, s60, s20
    s_cmp_lg_u32 s66, 0
    s_cbranch_scc1 L_w2f
    s_add_u32 s66, s70, 80871424
    v_mov_b32 v12, s64
    v_lshlrev_b32 v13, 10, v2
    s_mov_b64 exec, 0xff
    buffer_store_dword v12, v13, s[32:35], s66 offen sc1
    s_mov_b64 exec, -1
L_w2f:
    s_waitcnt lgkmcnt(0)
    v_mfma_f32_16x16x32_bf16 v[132:135], v[32:35], v[16:19], v[132:135]
    ds_read_b128 v[76:79], v9 offset:14336
    v_mfma_f32_16x16x32_bf16 v[136:139], v[32:35], v[20:23], v[136:139]
    ds_read_b128 v[60:63], v6 offset:8192
    v_mfma_f32_16x16x32_bf16 v[140:143], v[32:35], v[24:27], v[140:143]
    ds_read_b128 v[64:67], v6 offset:9216
    v_mfma_f32_16x16x32_bf16 v[144:147], v[32:35], v[28:31], v[144:147]
    ds_read_b128 v[68:71], v6 offset:10240
    v_mfma_f32_16x16x32_bf16 v[148:151], v[36:39], v[16:19], v[148:151]
    ds_read_b128 v[72:75], v6 offset:11264
    v_mfma_f32_16x16x32_bf16 v[152:155], v[36:39], v[20:23], v[152:155]
    ds_read_b128 v[80:83], v9 offset:15360
    v_mfma_f32_16x16x32_bf16 v[156:159], v[36:39], v[24:27], v[156:159]
    ds_read_b128 v[84:87], v9 offset:16384
    v_mfma_f32_16x16x32_bf16 v[160:163], v[36:39], v[28:31], v[160:163]
    ds_read_b128 v[88:91], v9 offset:17408
    v_mfma_f32_16x16x32_bf16 v[164:167], v[40:43], v[16:19], v[164:167]
    ds_read_b128 v[92:95], v9 offset:18432
    v_mfma_f32_16x16x32_bf16 v[168:171], v[40:43], v[20:23], v[168:171]
    ds_read_b128 v[96:99], v9 offset:19456
    v_mfma_f32_16x16x32_bf16 v[172:175], v[40:43], v[24:27], v[172:175]
    ds_read_b128 v[100:103], v9 offset:20480
    v_mfma_f32_16x16x32_bf16 v[176:179], v[40:43], v[28:31], v[176:179]
    s_add_u32 s36, s36, 45056
    s_cmp_eq_u32 s36, 135168
    s_cselect_b32 s36, 0, s36
    v_mfma_f32_16x16x32_bf16 v[180:183], v[44:47], v[16:19], v[180:183]
    v_add_u32 v6, s36, v5
    v_mfma_f32_16x16x32_bf16 v[184:187], v[44:47], v[20:23], v[184:187]
    v_add_u32 v9, s36, v8
    v_mfma_f32_16x16x32_bf16 v[188:191], v[44:47], v[24:27], v[188:191]
    v_mfma_f32_16x16x32_bf16 v[192:195], v[44:47], v[28:31], v[192:195]
    v_mfma_f32_16x16x32_bf16 v[196:199], v[48:51], v[16:19], v[196:199]
    v_mfma_f32_16x16x32_bf16 v[200:203], v[48:51], v[20:23], v[200:203]
    s_waitcnt vmcnt(11) lgkmcnt(0)
    s_barrier
    v_mfma_f32_16x16x32_bf16 v[204:207], v[48:51], v[24:27], v[204:207]
    v_mfma_f32_16x16x32_bf16 v[208:211], v[48:51], v[28:31], v[208:211]
    v_mfma_f32_16x16x32_bf16 v[212:215], v[52:55], v[16:19], v[212:215]
    v_mfma_f32_16x16x32_bf16 v[216:219], v[52:55], v[20:23], v[216:219]
    v_mfma_f32_16x16x32_bf16 v[220:223], v[52:55], v[24:27], v[220:223]
    v_mfma_f32_16x16x32_bf16 v[224:227], v[52:55], v[28:31], v[224:227]
    v_mfma_f32_16x16x32_bf16 v[228:231], v[56:59], v[16:19], v[228:231]
    v_mfma_f32_16x16x32_bf16 v[232:235], v[56:59], v[20:23], v[232:235]
    v_mfma_f32_16x16x32_bf16 v[236:239], v[56:59], v[24:27], v[236:239]
    v_mfma_f32_16x16x32_bf16 v[240:243], v[56:59], v[28:31], v[240:243]
    v_mfma_f32_16x16x32_bf16 v[132:135], v[76:79], v[60:63], v[132:135]
    ds_read_b128 v[32:35], v9 offset:0
    v_mfma_f32_16x16x32_bf16 v[136:139], v[76:79], v[64:67], v[136:139]
    ds_read_b128 v[16:19], v6 offset:0
    v_mfma_f32_16x16x32_bf16 v[140:143], v[76:79], v[68:71], v[140:143]
    ds_read_b128 v[20:23], v6 offset:1024
    v_mfma_f32_16x16x32_bf16 v[144:147], v[76:79], v[72:75], v[144:147]
    ds_read_b128 v[24:27], v6 offset:2048
    v_mfma_f32_16x16x32_bf16 v[148:151], v[80:83], v[60:63], v[148:151]
    ds_read_b128 v[28:31], v6 offset:3072
    v_mfma_f32_16x16x32_bf16 v[152:155], v[80:83], v[64:67], v[152:155]
    ds_read_b128 v[36:39], v9 offset:1024
    v_mfma_f32_16x16x32_bf16 v[156:159], v[80:83], v[68:71], v[156:159]
    ds_read_b128 v[40:43], v9 offset:2048
    v_mfma_f32_16x16x32_bf16 v[160:163], v[80:83], v[72:75], v[160:163]
    ds_read_b128 v[44:47], v9 offset:3072
    v_mfma_f32_16x16x32_bf16 v[164:167], v[84:87], v[60:63], v[164:167]
    ds_read_b128 v[48:51], v9 offset:4096
    v_mfma_f32_16x16x32_bf16 v[168:171], v[84:87], v[64:67], v[168:171]
    ds_read_b128 v[52:55], v9 offset:5120
    v_mfma_f32_16x16x32_bf16 v[172:175], v[84:87], v[68:71], v[172:175]
    ds_read_b128 v[56:59], v9 offset:6144
    v_mfma_f32_16x16x32_bf16 v[176:179], v[84:87], v[72:75], v[176:179]
    v_mfma_f32_16x16x32_bf16 v[180:183], v[88:91], v[60:63], v[180:183]
    v_mfma_f32_16x16x32_bf16 v[184:187], v[88:91], v[64:67], v[184:187]
    v_mfma_f32_16x16x32_bf16 v[188:191], v[88:91], v[68:71], v[188:191]
    v_mfma_f32_16x16x32_bf16 v[192:195], v[88:91], v[72:75], v[192:195]
    v_mfma_f32_16x16x32_bf16 v[196:199], v[92:95], v[60:63], v[196:199]
    v_mfma_f32_16x16x32_bf16 v[200:203], v[92:95], v[64:67], v[200:203]
    v_mfma_f32_16x16x32_bf16 v[204:207], v[92:95], v[68:71], v[204:207]
    v_mfma_f32_16x16x32_bf16 v[208:211], v[92:95], v[72:75], v[208:211]
    v_mfma_f32_16x16x32_bf16 v[212:215], v[96:99], v[60:63], v[212:215]
    v_mfma_f32_16x16x32_bf16 v[216:219], v[96:99], v[64:67], v[216:219]
    v_mfma_f32_16x16x32_bf16 v[220:223], v[96:99], v[68:71], v[220:223]
    v_mfma_f32_16x16x32_bf16 v[224:227], v[96:99], v[72:75], v[224:227]
    v_mfma_f32_16x16x32_bf16 v[228:231], v[100:103], v[60:63], v[228:231]
    v_mfma_f32_16x16x32_bf16 v[232:235], v[100:103], v[64:67], v[232:235]
    v_mfma_f32_16x16x32_bf16 v[236:239], v[100:103], v[68:71], v[236:239]
    v_mfma_f32_16x16x32_bf16 v[240:243], v[100:103], v[72:75], v[240:243]
    s_waitcnt lgkmcnt(0)
    v_mfma_f32_16x16x32_bf16 v[132:135], v[32:35], v[16:19], v[132:135]
    ds_read_b128 v[76:79], v9 offset:14336
    v_mfma_f32_16x16x32_bf16 v[136:139], v[32:35], v[20:23], v[136:139]
    ds_read_b128 v[60:63], v6 offset:8192
    v_mfma_f32_16x16x32_bf16 v[140:143], v[32:35], v[24:27], v[140:143]
    ds_read_b128 v[64:67], v6 offset:9216
    v_mfma_f32_16x16x32_bf16 v[144:147], v[32:35], v[28:31], v[144:147]
    ds_read_b128 v[68:71], v6 offset:10240
    v_mfma_f32_16x16x32_bf16 v[148:151], v[36:39], v[16:19], v[148:151]
    ds_read_b128 v[72:75], v6 offset:11264
    v_mfma_f32_16x16x32_bf16 v[152:155], v[36:39], v[20:23], v[152:155]
    ds_read_b128 v[80:83], v9 offset:15360
    v_mfma_f32_16x16x32_bf16 v[156:159], v[36:39], v[24:27], v[156:159]
    ds_read_b128 v[84:87], v9 offset:16384
    v_mfma_f32_16x16x32_bf16 v[160:163], v[36:39], v[28:31], v[160:163]
    ds_read_b128 v[88:91], v9 offset:17408
    v_mfma_f32_16x16x32_bf16 v[164:167], v[40:43], v[16:19], v[164:167]
    ds_read_b128 v[92:95], v9 offset:18432
    v_mfma_f32_16x16x32_bf16 v[168:171], v[40:43], v[20:23], v[168:171]
    ds_read_b128 v[96:99], v9 offset:19456
    v_mfma_f32_16x16x32_bf16 v[172:175], v[40:43], v[24:27], v[172:175]
    ds_read_b128 v[100:103], v9 offset:20480
    v_mfma_f32_16x16x32_bf16 v[176:179], v[40:43], v[28:31], v[176:179]
    s_add_u32 s36, s36, 45056
    s_cmp_eq_u32 s36, 135168
    s_cselect_b32 s36, 0, s36
    v_mfma_f32_16x16x32_bf16 v[180:183], v[44:47], v[16:19], v[180:183]
    v_add_u32 v6, s36, v5
    v_mfma_f32_16x16x32_bf16 v[184:187], v[44:47], v[20:23], v[184:187]
    v_add_u32 v9, s36, v8
    v_mfma_f32_16x16x32_bf16 v[188:191], v[44:47], v[24:27], v[188:191]
    v_mfma_f32_16x16x32_bf16 v[192:195], v[44:47], v[28:31], v[192:195]
    v_mfma_f32_16x16x32_bf16 v[196:199], v[48:51], v[16:19], v[196:199]
    v_mfma_f32_16x16x32_bf16 v[200:203], v[48:51], v[20:23], v[200:203]
    s_waitcnt vmcnt(0) lgkmcnt(0)
    s_barrier
    v_mfma_f32_16x16x32_bf16 v[204:207], v[48:51], v[24:27], v[204:207]
    v_mfma_f32_16x16x32_bf16 v[208:211], v[48:51], v[28:31], v[208:211]
    v_mfma_f32_16x16x32_bf16 v[212:215], v[52:55], v[16:19], v[212:215]
    v_mfma_f32_16x16x32_bf16 v[216:219], v[52:55], v[20:23], v[216:219]
    v_mfma_f32_16x16x32_bf16 v[220:223], v[52:55], v[24:27], v[220:223]
    v_mfma_f32_16x16x32_bf16 v[224:227], v[52:55], v[28:31], v[224:227]
    v_mfma_f32_16x16x32_bf16 v[228:231], v[56:59], v[16:19], v[228:231]
    v_mfma_f32_16x16x32_bf16 v[232:235], v[56:59], v[20:23], v[232:235]
    v_mfma_f32_16x16x32_bf16 v[236:239], v[56:59], v[24:27], v[236:239]
    v_mfma_f32_16x16x32_bf16 v[240:243], v[56:59], v[28:31], v[240:243]
    v_mfma_f32_16x16x32_bf16 v[132:135], v[76:79], v[60:63], v[132:135]
    ds_read_b128 v[32:35], v9 offset:0
    v_mfma_f32_16x16x32_bf16 v[136:139], v[76:79], v[64:67], v[136:139]
    ds_read_b128 v[16:19], v6 offset:0
    v_mfma_f32_16x16x32_bf16 v[140:143], v[76:79], v[68:71], v[140:143]
    ds_read_b128 v[20:23], v6 offset:1024
    v_mfma_f32_16x16x32_bf16 v[144:147], v[76:79], v[72:75], v[144:147]
    ds_read_b128 v[24:27], v6 offset:2048
    v_mfma_f32_16x16x32_bf16 v[148:151], v[80:83], v[60:63], v[148:151]
    ds_read_b128 v[28:31], v6 offset:3072
    v_mfma_f32_16x16x32_bf16 v[152:155], v[80:83], v[64:67], v[152:155]
    ds_read_b128 v[36:39], v9 offset:1024
    v_mfma_f32_16x16x32_bf16 v[156:159], v[80:83], v[68:71], v[156:159]
    ds_read_b128 v[40:43], v9 offset:2048
    v_mfma_f32_16x16x32_bf16 v[160:163], v[80:83], v[72:75], v[160:163]
    ds_read_b128 v[44:47], v9 offset:3072
    v_mfma_f32_16x16x32_bf16 v[164:167], v[84:87], v[60:63], v[164:167]
    ds_read_b128 v[48:51], v9 offset:4096
    v_mfma_f32_16x16x32_bf16 v[168:171], v[84:87], v[64:67], v[168:171]
    ds_read_b128 v[52:55], v9 offset:5120
    v_mfma_f32_16x16x32_bf16 v[172:175], v[84:87], v[68:71], v[172:175]
    ds_read_b128 v[56:59], v9 offset:6144
    v_mfma_f32_16x16x32_bf16 v[176:179], v[84:87], v[72:75], v[176:179]
    v_mfma_f32_16x16x32_bf16 v[180:183], v[88:91], v[60:63], v[180:183]
    v_mfma_f32_16x16x32_bf16 v[184:187], v[88:91], v[64:67], v[184:187]
    v_mfma_f32_16x16x32_bf16 v[188:191], v[88:91], v[68:71], v[188:191]
    v_mfma_f32_16x16x32_bf16 v[192:195], v[88:91], v[72:75], v[192:195]
    v_mfma_f32_16x16x32_bf16 v[196:199], v[92:95], v[60:63], v[196:199]
    v_mfma_f32_16x16x32_bf16 v[200:203], v[92:95], v[64:67], v[200:203]
    v_mfma_f32_16x16x32_bf16 v[204:207], v[92:95], v[68:71], v[204:207]
    v_mfma_f32_16x16x32_bf16 v[208:211], v[92:95], v[72:75], v[208:211]
    v_mfma_f32_16x16x32_bf16 v[212:215], v[96:99], v[60:63], v[212:215]
    v_mfma_f32_16x16x32_bf16 v[216:219], v[96:99], v[64:67], v[216:219]
    v_mfma_f32_16x16x32_bf16 v[220:223], v[96:99], v[68:71], v[220:223]
    v_mfma_f32_16x16x32_bf16 v[224:227], v[96:99], v[72:75], v[224:227]
    v_mfma_f32_16x16x32_bf16 v[228:231], v[100:103], v[60:63], v[228:231]
    v_mfma_f32_16x16x32_bf16 v[232:235], v[100:103], v[64:67], v[232:235]
    v_mfma_f32_16x16x32_bf16 v[236:239], v[100:103], v[68:71], v[236:239]
    v_mfma_f32_16x16x32_bf16 v[240:243], v[100:103], v[72:75], v[240:243]
    s_waitcnt lgkmcnt(0)
    v_mfma_f32_16x16x32_bf16 v[132:135], v[32:35], v[16:19], v[132:135]
    ds_read_b128 v[76:79], v9 offset:14336
    v_mfma_f32_16x16x32_bf16 v[136:139], v[32:35], v[20:23], v[136:139]
    ds_read_b128 v[60:63], v6 offset:8192
    v_mfma_f32_16x16x32_bf16 v[140:143], v[32:35], v[24:27], v[140:143]
    ds_read_b128 v[64:67], v6 offset:9216
    v_mfma_f32_16x16x32_bf16 v[144:147], v[32:35], v[28:31], v[144:147]
    ds_read_b128 v[68:71], v6 offset:10240
    v_mfma_f32_16x16x32_bf16 v[148:151], v[36:39], v[16:19], v[148:151]
    ds_read_b128 v[72:75], v6 offset:11264
    v_mfma_f32_16x16x32_bf16 v[152:155], v[36:39], v[20:23], v[152:155]
    ds_read_b128 v[80:83], v9 offset:15360
    v_mfma_f32_16x16x32_bf16 v[156:159], v[36:39], v[24:27], v[156:159]
    ds_read_b128 v[84:87], v9 offset:16384
    v_mfma_f32_16x16x32_bf16 v[160:163], v[36:39], v[28:31], v[160:163]
    ds_read_b128 v[88:91], v9 offset:17408
    v_mfma_f32_16x16x32_bf16 v[164:167], v[40:43], v[16:19], v[164:167]
    ds_read_b128 v[92:95], v9 offset:18432
    v_mfma_f32_16x16x32_bf16 v[168:171], v[40:43], v[20:23], v[168:171]
    ds_read_b128 v[96:99], v9 offset:19456
    v_mfma_f32_16x16x32_bf16 v[172:175], v[40:43], v[24:27], v[172:175]
    ds_read_b128 v[100:103], v9 offset:20480
    v_mfma_f32_16x16x32_bf16 v[176:179], v[40:43], v[28:31], v[176:179]
    s_cmp_eq_u32 s22, 1
    s_cbranch_scc1 L_ep1_g1
    v_mfma_f32_16x16x32_bf16 v[180:183], v[44:47], v[16:19], v[180:183]
    v_mfma_f32_16x16x32_bf16 v[184:187], v[44:47], v[20:23], v[184:187]
    v_mfma_f32_16x16x32_bf16 v[188:191], v[44:47], v[24:27], v[188:191]
    v_mfma_f32_16x16x32_bf16 v[192:195], v[44:47], v[28:31], v[192:195]
    s_waitcnt lgkmcnt(0)
    v_mfma_f32_16x16x32_bf16 v[132:135], v[76:79], v[60:63], v[132:135]
    v_mfma_f32_16x16x32_bf16 v[136:139], v[76:79], v[64:67], v[136:139]
    v_mfma_f32_16x16x32_bf16 v[140:143], v[76:79], v[68:71], v[140:143]
    v_mfma_f32_16x16x32_bf16 v[144:147], v[76:79], v[72:75], v[144:147]
    v_mfma_f32_16x16x32_bf16 v[148:151], v[80:83], v[60:63], v[148:151]
    v_mfma_f32_16x16x32_bf16 v[152:155], v[80:83], v[64:67], v[152:155]
    v_mfma_f32_16x16x32_bf16 v[156:159], v[80:83], v[68:71], v[156:159]
    v_mfma_f32_16x16x32_bf16 v[160:163], v[80:83], v[72:75], v[160:163]
    v_mfma_f32_16x16x32_bf16 v[164:167], v[84:87], v[60:63], v[164:167]
    v_mfma_f32_16x16x32_bf16 v[168:171], v[84:87], v[64:67], v[168:171]
    v_mfma_f32_16x16x32_bf16 v[172:175], v[84:87], v[68:71], v[172:175]
    v_mfma_f32_16x16x32_bf16 v[176:179], v[84:87], v[72:75], v[176:179]
    v_max_f32 v132, 0, v132
    v_max_f32 v133, 0, v133
    v_max_f32 v134, 0, v134
    v_mfma_f32_16x16x32_bf16 v[180:183], v[88:91], v[60:63], v[180:183]
    v_max_f32 v135, 0, v135
    v_pk_mul_f32 v[132:133], v[132:133], v[132:133]
    v_pk_mul_f32 v[134:135], v[134:135], v[134:135]
    v_mfma_f32_16x16x32_bf16 v[184:187], v[88:91], v[64:67], v[184:187]
    v_cvt_pk_bf16_f32 v104, v132, v133
    v_cvt_pk_bf16_f32 v105, v134, v135
    v_max_f32 v148, 0, v148
    v_mfma_f32_16x16x32_bf16 v[188:191], v[88:91], v[68:71], v[188:191]
    v_max_f32 v149, 0, v149
    v_max_f32 v150, 0, v150
    v_max_f32 v151, 0, v151
    v_mfma_f32_16x16x32_bf16 v[192:195], v[88:91], v[72:75], v[192:195]
    v_pk_mul_f32 v[148:149], v[148:149], v[148:149]
    v_pk_mul_f32 v[150:151], v[150:151], v[150:151]
    v_cvt_pk_bf16_f32 v106, v148, v149
    v_mfma_f32_16x16x32_bf16 v[196:199], v[48:51], v[16:19], v[196:199]
    v_cvt_pk_bf16_f32 v107, v150, v151
    s_add_u32 s27, s26, 0
    buffer_store_dwordx4 v[104:107], v3, s[32:35], s27 offen offset:0 sc1
    v_max_f32 v136, 0, v136
    v_mfma_f32_16x16x32_bf16 v[200:203], v[48:51], v[20:23], v[200:203]
    v_max_f32 v137, 0, v137
    v_max_f32 v138, 0, v138
    v_max_f32 v139, 0, v139
    v_mfma_f32_16x16x32_bf16 v[204:207], v[48:51], v[24:27], v[204:207]
    v_pk_mul_f32 v[136:137], v[136:137], v[136:137]
    v_pk_mul_f32 v[138:139], v[138:139], v[138:139]
    v_cvt_pk_bf16_f32 v108, v136, v137
    v_mfma_f32_16x16x32_bf16 v[208:211], v[48:51], v[28:31], v[208:211]
    v_cvt_pk_bf16_f32 v109, v138, v139
    v_max_f32 v152, 0, v152
    v_max_f32 v153, 0, v153
    v_mfma_f32_16x16x32_bf16 v[196:199], v[92:95], v[60:63], v[196:199]
    v_max_f32 v154, 0, v154
    v_max_f32 v155, 0, v155
    v_pk_mul_f32 v[152:153], v[152:153], v[152:153]
    v_mfma_f32_16x16x32_bf16 v[200:203], v[92:95], v[64:67], v[200:203]
    v_pk_mul_f32 v[154:155], v[154:155], v[154:155]
    v_cvt_pk_bf16_f32 v110, v152, v153
    v_cvt_pk_bf16_f32 v111, v154, v155
    v_mfma_f32_16x16x32_bf16 v[204:207], v[92:95], v[68:71], v[204:207]
    s_add_u32 s27, s26, 0
    buffer_store_dwordx4 v[108:111], v3, s[32:35], s27 offen offset:1024 sc1
    v_max_f32 v140, 0, v140
    v_max_f32 v141, 0, v141
    v_mfma_f32_16x16x32_bf16 v[208:211], v[92:95], v[72:75], v[208:211]
    v_max_f32 v142, 0, v142
    v_max_f32 v143, 0, v143
    v_pk_mul_f32 v[140:141], v[140:141], v[140:141]
    v_mfma_f32_16x16x32_bf16 v[212:215], v[52:55], v[16:19], v[212:215]
    v_pk_mul_f32 v[142:143], v[142:143], v[142:143]
    v_cvt_pk_bf16_f32 v112, v140, v141
    v_cvt_pk_bf16_f32 v113, v142, v143
    v_mfma_f32_16x16x32_bf16 v[216:219], v[52:55], v[20:23], v[216:219]
    v_max_f32 v156, 0, v156
    v_max_f32 v157, 0, v157
    v_max_f32 v158, 0, v158
    v_mfma_f32_16x16x32_bf16 v[220:223], v[52:55], v[24:27], v[220:223]
    v_max_f32 v159, 0, v159
    v_pk_mul_f32 v[156:157], v[156:157], v[156:157]
    v_pk_mul_f32 v[158:159], v[158:159], v[158:159]
    v_mfma_f32_16x16x32_bf16 v[224:227], v[52:55], v[28:31], v[224:227]
    v_cvt_pk_bf16_f32 v114, v156, v157
    v_cvt_pk_bf16_f32 v115, v158, v159
    s_add_u32 s27, s26, 0
    buffer_store_dwordx4 v[112:115], v3, s[32:35], s27 offen offset:2048 sc1
    v_mfma_f32_16x16x32_bf16 v[212:215], v[96:99], v[60:63], v[212:215]
    v_max_f32 v144, 0, v144
    v_max_f32 v145, 0, v145
    v_max_f32 v146, 0, v146
    v_mfma_f32_16x16x32_bf16 v[216:219], v[96:99], v[64:67], v[216:219]
    v_max_f32 v147, 0, v147
    v_pk_mul_f32 v[144:145], v[144:145], v[144:145]
    v_pk_mul_f32 v[146:147], v[146:147], v[146:147]
    v_mfma_f32_16x16x32_bf16 v[220:223], v[96:99], v[68:71], v[220:223]
    v_cvt_pk_bf16_f32 v116, v144, v145
    v_cvt_pk_bf16_f32 v117, v146, v147
    v_max_f32 v160, 0, v160
    v_mfma_f32_16x16x32_bf16 v[224:227], v[96:99], v[72:75], v[224:227]
    v_max_f32 v161, 0, v161
    v_max_f32 v162, 0, v162
    v_max_f32 v163, 0, v163
    v_mfma_f32_16x16x32_bf16 v[228:231], v[56:59], v[16:19], v[228:231]
    v_pk_mul_f32 v[160:161], v[160:161], v[160:161]
    v_pk_mul_f32 v[162:163], v[162:163], v[162:163]
    v_cvt_pk_bf16_f32 v118, v160, v161
    v_mfma_f32_16x16x32_bf16 v[232:235], v[56:59], v[20:23], v[232:235]
    v_cvt_pk_bf16_f32 v119, v162, v163
    s_add_u32 s27, s26, 0
    buffer_store_dwordx4 v[116:119], v3, s[32:35], s27 offen offset:3072 sc1
    v_max_f32 v164, 0, v164
    v_mfma_f32_16x16x32_bf16 v[236:239], v[56:59], v[24:27], v[236:239]
    v_max_f32 v165, 0, v165
    v_max_f32 v166, 0, v166
    v_max_f32 v167, 0, v167
    v_mfma_f32_16x16x32_bf16 v[240:243], v[56:59], v[28:31], v[240:243]
    v_pk_mul_f32 v[164:165], v[164:165], v[164:165]
    v_pk_mul_f32 v[166:167], v[166:167], v[166:167]
    v_cvt_pk_bf16_f32 v120, v164, v165
    v_mfma_f32_16x16x32_bf16 v[228:231], v[100:103], v[60:63], v[228:231]
    v_cvt_pk_bf16_f32 v121, v166, v167
    v_max_f32 v180, 0, v180
    v_max_f32 v181, 0, v181
    v_mfma_f32_16x16x32_bf16 v[232:235], v[100:103], v[64:67], v[232:235]
    v_max_f32 v182, 0, v182
    v_max_f32 v183, 0, v183
    v_pk_mul_f32 v[180:181], v[180:181], v[180:181]
    v_mfma_f32_16x16x32_bf16 v[236:239], v[100:103], v[68:71], v[236:239]
    v_pk_mul_f32 v[182:183], v[182:183], v[182:183]
    v_cvt_pk_bf16_f32 v122, v180, v181
    v_cvt_pk_bf16_f32 v123, v182, v183
    v_mfma_f32_16x16x32_bf16 v[240:243], v[100:103], v[72:75], v[240:243]
    s_add_u32 s27, s26, 8192
    buffer_store_dwordx4 v[120:123], v3, s[32:35], s27 offen offset:0 sc1
    v_max_f32 v168, 0, v168
    v_max_f32 v169, 0, v169
    v_max_f32 v170, 0, v170
    v_max_f32 v171, 0, v171
    v_pk_mul_f32 v[168:169], v[168:169], v[168:169]
    v_pk_mul_f32 v[170:171], v[170:171], v[170:171]
    v_cvt_pk_bf16_f32 v124, v168, v169
    v_cvt_pk_bf16_f32 v125, v170, v171
    v_max_f32 v184, 0, v184
    v_max_f32 v185, 0, v185
    v_max_f32 v186, 0, v186
    v_max_f32 v187, 0, v187
    v_pk_mul_f32 v[184:185], v[184:185], v[184:185]
    v_pk_mul_f32 v[186:187], v[186:187], v[186:187]
    v_cvt_pk_bf16_f32 v126, v184, v185
    v_cvt_pk_bf16_f32 v127, v186, v187
    s_add_u32 s27, s26, 8192
    buffer_store_dwordx4 v[124:127], v3, s[32:35], s27 offen offset:1024 sc1
    v_max_f32 v172, 0, v172
    v_max_f32 v173, 0, v173
    v_max_f32 v174, 0, v174
    v_max_f32 v175, 0, v175
    v_pk_mul_f32 v[172:173], v[172:173], v[172:173]
    v_pk_mul_f32 v[174:175], v[174:175], v[174:175]
    v_cvt_pk_bf16_f32 v128, v172, v173
    v_cvt_pk_bf16_f32 v129, v174, v175
    v_max_f32 v188, 0, v188
    v_max_f32 v189, 0, v189
    v_max_f32 v190, 0, v190
    v_max_f32 v191, 0, v191
    v_pk_mul_f32 v[188:189], v[188:189], v[188:189]
    v_pk_mul_f32 v[190:191], v[190:191], v[190:191]
    v_cvt_pk_bf16_f32 v130, v188, v189
    v_cvt_pk_bf16_f32 v131, v190, v191
    s_add_u32 s27, s26, 8192
    buffer_store_dwordx4 v[128:131], v3, s[32:35], s27 offen offset:2048 sc1
    v_max_f32 v176, 0, v176
    v_max_f32 v177, 0, v177
    v_max_f32 v178, 0, v178
    v_max_f32 v179, 0, v179
    v_pk_mul_f32 v[176:177], v[176:177], v[176:177]
    v_pk_mul_f32 v[178:179], v[178:179], v[178:179]
    v_cvt_pk_bf16_f32 v104, v176, v177
    v_cvt_pk_bf16_f32 v105, v178, v179
    v_max_f32 v192, 0, v192
    v_max_f32 v193, 0, v193
    v_max_f32 v194, 0, v194
    v_max_f32 v195, 0, v195
    v_pk_mul_f32 v[192:193], v[192:193], v[192:193]
    v_pk_mul_f32 v[194:195], v[194:195], v[194:195]
    v_cvt_pk_bf16_f32 v106, v192, v193
    v_cvt_pk_bf16_f32 v107, v194, v195
    s_add_u32 s27, s26, 8192
    buffer_store_dwordx4 v[104:107], v3, s[32:35], s27 offen offset:3072 sc1
    v_max_f32 v196, 0, v196
    v_max_f32 v197, 0, v197
    v_max_f32 v198, 0, v198
    v_max_f32 v199, 0, v199
    v_pk_mul_f32 v[196:197], v[196:197], v[196:197]
    v_pk_mul_f32 v[198:199], v[198:199], v[198:199]
    v_cvt_pk_bf16_f32 v108, v196, v197
    v_cvt_pk_bf16_f32 v109, v198, v199
    v_max_f32 v212, 0, v212
    v_max_f32 v213, 0, v213
    v_max_f32 v214, 0, v214
    v_max_f32 v215, 0, v215
    v_pk_mul_f32 v[212:213], v[212:213], v[212:213]
    v_pk_mul_f32 v[214:215], v[214:215], v[214:215]
    v_cvt_pk_bf16_f32 v110, v212, v213
    v_cvt_pk_bf16_f32 v111, v214, v215
    s_add_u32 s27, s26, 16384
    buffer_store_dwordx4 v[108:111], v3, s[32:35], s27 offen offset:0 sc1
    v_max_f32 v200, 0, v200
    v_max_f32 v201, 0, v201
    v_max_f32 v202, 0, v202
    v_max_f32 v203, 0, v203
    v_pk_mul_f32 v[200:201], v[200:201], v[200:201]
    v_pk_mul_f32 v[202:203], v[202:203], v[202:203]
    v_cvt_pk_bf16_f32 v112, v200, v201
    v_cvt_pk_bf16_f32 v113, v202, v203
    v_max_f32 v216, 0, v216
    v_max_f32 v217, 0, v217
    v_max_f32 v218, 0, v218
    v_max_f32 v219, 0, v219
    v_pk_mul_f32 v[216:217], v[216:217], v[216:217]
    v_pk_mul_f32 v[218:219], v[218:219], v[218:219]
    v_cvt_pk_bf16_f32 v114, v216, v217
    v_cvt_pk_bf16_f32 v115, v218, v219
    s_add_u32 s27, s26, 16384
    buffer_store_dwordx4 v[112:115], v3, s[32:35], s27 offen offset:1024 sc1
    v_max_f32 v204, 0, v204
    v_max_f32 v205, 0, v205
    v_max_f32 v206, 0, v206
    v_max_f32 v207, 0, v207
    v_pk_mul_f32 v[204:205], v[204:205], v[204:205]
    v_pk_mul_f32 v[206:207], v[206:207], v[206:207]
    v_cvt_pk_bf16_f32 v116, v204, v205
    v_cvt_pk_bf16_f32 v117, v206, v207
    v_max_f32 v220, 0, v220
    v_max_f32 v221, 0, v221
    v_max_f32 v222, 0, v222
    v_max_f32 v223, 0, v223
    v_pk_mul_f32 v[220:221], v[220:221], v[220:221]
    v_pk_mul_f32 v[222:223], v[222:223], v[222:223]
    v_cvt_pk_bf16_f32 v118, v220, v221
    v_cvt_pk_bf16_f32 v119, v222, v223
    s_add_u32 s27, s26, 16384
    buffer_store_dwordx4 v[116:119], v3, s[32:35], s27 offen offset:2048 sc1
    v_max_f32 v208, 0, v208
    v_max_f32 v209, 0, v209
    v_max_f32 v210, 0, v210
    v_max_f32 v211, 0, v211
    v_pk_mul_f32 v[208:209], v[208:209], v[208:209]
    v_pk_mul_f32 v[210:211], v[210:211], v[210:211]
    v_cvt_pk_bf16_f32 v120, v208, v209
    v_cvt_pk_bf16_f32 v121, v210, v211
    v_max_f32 v224, 0, v224
    v_max_f32 v225, 0, v225
    v_max_f32 v226, 0, v226
    v_max_f32 v227, 0, v227
    v_pk_mul_f32 v[224:225], v[224:225], v[224:225]
    v_pk_mul_f32 v[226:227], v[226:227], v[226:227]
    v_cvt_pk_bf16_f32 v122, v224, v225
    v_cvt_pk_bf16_f32 v123, v226, v227
    s_add_u32 s27, s26, 16384
    buffer_store_dwordx4 v[120:123], v3, s[32:35], s27 offen offset:3072 sc1
    v_max_f32 v228, 0, v228
    v_max_f32 v229, 0, v229
    v_max_f32 v230, 0, v230
    v_max_f32 v231, 0, v231
    v_pk_mul_f32 v[228:229], v[228:229], v[228:229]
    v_pk_mul_f32 v[230:231], v[230:231], v[230:231]
    v_cvt_pk_bf16_f32 v124, v228, v229
    v_cvt_pk_bf16_f32 v125, v230, v231
    s_add_u32 s27, s26, 24576
    buffer_store_dwordx2 v[124:125], v3, s[32:35], s27 offen offset:0 sc1
    v_max_f32 v232, 0, v232
    v_max_f32 v233, 0, v233
    v_max_f32 v234, 0, v234
    v_max_f32 v235, 0, v235
    v_pk_mul_f32 v[232:233], v[232:233], v[232:233]
    v_pk_mul_f32 v[234:235], v[234:235], v[234:235]
    v_cvt_pk_bf16_f32 v128, v232, v233
    v_cvt_pk_bf16_f32 v129, v234, v235
    s_add_u32 s27, s26, 24576
    buffer_store_dwordx2 v[128:129], v3, s[32:35], s27 offen offset:1024 sc1
    v_max_f32 v236, 0, v236
    v_max_f32 v237, 0, v237
    v_max_f32 v238, 0, v238
    v_max_f32 v239, 0, v239
    v_pk_mul_f32 v[236:237], v[236:237], v[236:237]
    v_pk_mul_f32 v[238:239], v[238:239], v[238:239]
    v_cvt_pk_bf16_f32 v104, v236, v237
    v_cvt_pk_bf16_f32 v105, v238, v239
    s_add_u32 s27, s26, 24576
    buffer_store_dwordx2 v[104:105], v3, s[32:35], s27 offen offset:2048 sc1
    v_max_f32 v240, 0, v240
    v_max_f32 v241, 0, v241
    v_max_f32 v242, 0, v242
    v_max_f32 v243, 0, v243
    v_pk_mul_f32 v[240:241], v[240:241], v[240:241]
    v_pk_mul_f32 v[242:243], v[242:243], v[242:243]
    v_cvt_pk_bf16_f32 v108, v240, v241
    v_cvt_pk_bf16_f32 v109, v242, v243
    s_add_u32 s27, s26, 24576
    buffer_store_dwordx2 v[108:109], v3, s[32:35], s27 offen offset:3072 sc1
    s_branch L_epd_g1
L_ep1_g1:
    v_mfma_f32_16x16x32_bf16 v[180:183], v[44:47], v[16:19], v[180:183]
    v_mfma_f32_16x16x32_bf16 v[184:187], v[44:47], v[20:23], v[184:187]
    v_mfma_f32_16x16x32_bf16 v[188:191], v[44:47], v[24:27], v[188:191]
    v_mfma_f32_16x16x32_bf16 v[192:195], v[44:47], v[28:31], v[192:195]
    s_waitcnt lgkmcnt(0)
    v_mfma_f32_16x16x32_bf16 v[132:135], v[76:79], v[60:63], v[132:135]
    v_mfma_f32_16x16x32_bf16 v[136:139], v[76:79], v[64:67], v[136:139]
    v_mfma_f32_16x16x32_bf16 v[140:143], v[76:79], v[68:71], v[140:143]
    v_mfma_f32_16x16x32_bf16 v[144:147], v[76:79], v[72:75], v[144:147]
    v_mfma_f32_16x16x32_bf16 v[148:151], v[80:83], v[60:63], v[148:151]
    v_mfma_f32_16x16x32_bf16 v[152:155], v[80:83], v[64:67], v[152:155]
    v_mfma_f32_16x16x32_bf16 v[156:159], v[80:83], v[68:71], v[156:159]
    v_mfma_f32_16x16x32_bf16 v[160:163], v[80:83], v[72:75], v[160:163]
    v_max_f32 v132, 0, v132
    v_max_f32 v133, 0, v133
    v_max_f32 v134, 0, v134
    v_mfma_f32_16x16x32_bf16 v[164:167], v[84:87], v[60:63], v[164:167]
    v_max_f32 v135, 0, v135
    v_pk_mul_f32 v[132:133], v[132:133], v[132:133]
    v_pk_mul_f32 v[134:135], v[134:135], v[134:135]
    v_mfma_f32_16x16x32_bf16 v[168:171], v[84:87], v[64:67], v[168:171]
    v_cvt_pk_bf16_f32 v104, v132, v133
    v_cvt_pk_bf16_f32 v105, v134, v135
    s_add_u32 s27, s26, 24576
    buffer_store_dwordx2 v[104:105], v3, s[32:35], s27 offen offset:8 sc1
    v_mfma_f32_16x16x32_bf16 v[172:175], v[84:87], v[68:71], v[172:175]
    v_max_f32 v136, 0, v136
    v_max_f32 v137, 0, v137
    v_max_f32 v138, 0, v138
    v_mfma_f32_16x16x32_bf16 v[176:179], v[84:87], v[72:75], v[176:179]
    v_max_f32 v139, 0, v139
    v_pk_mul_f32 v[136:137], v[136:137], v[136:137]
    v_pk_mul_f32 v[138:139], v[138:139], v[138:139]
    v_mfma_f32_16x16x32_bf16 v[180:183], v[88:91], v[60:63], v[180:183]
    v_cvt_pk_bf16_f32 v108, v136, v137
    v_cvt_pk_bf16_f32 v109, v138, v139
    s_add_u32 s27, s26, 24576
    buffer_store_dwordx2 v[108:109], v3, s[32:35], s27 offen offset:1032 sc1
    v_mfma_f32_16x16x32_bf16 v[184:187], v[88:91], v[64:67], v[184:187]
    v_max_f32 v140, 0, v140
    v_max_f32 v141, 0, v141
    v_max_f32 v142, 0, v142
    v_mfma_f32_16x16x32_bf16 v[188:191], v[88:91], v[68:71], v[188:191]
    v_max_f32 v143, 0, v143
    v_pk_mul_f32 v[140:141], v[140:141], v[140:141]
    v_pk_mul_f32 v[142:143], v[142:143], v[142:143]
    v_mfma_f32_16x16x32_bf16 v[192:195], v[88:91], v[72:75], v[192:195]
    v_cvt_pk_bf16_f32 v112, v140, v141
    v_cvt_pk_bf16_f32 v113, v142, v143
    s_add_u32 s27, s26, 24576
    buffer_store_dwordx2 v[112:113], v3, s[32:35], s27 offen offset:2056 sc1
    v_mfma_f32_16x16x32_bf16 v[196:199], v[48:51], v[16:19], v[196:199]
    v_max_f32 v144, 0, v144
    v_max_f32 v145, 0, v145
    v_max_f32 v146, 0, v146
    v_mfma_f32_16x16x32_bf16 v[200:203], v[48:51], v[20:23], v[200:203]
    v_max_f32 v147, 0, v147
    v_pk_mul_f32 v[144:145], v[144:145], v[144:145]
    v_pk_mul_f32 v[146:147], v[146:147], v[146:147]
    v_mfma_f32_16x16x32_bf16 v[204:207], v[48:51], v[24:27], v[204:207]
    v_cvt_pk_bf16_f32 v116, v144, v145
    v_cvt_pk_bf16_f32 v117, v146, v147
    s_add_u32 s27, s26, 24576
    buffer_store_dwordx2 v[116:117], v3, s[32:35], s27 offen offset:3080 sc1
    v_mfma_f32_16x16x32_bf16 v[208:211], v[48:51], v[28:31], v[208:211]
    v_max_f32 v148, 0, v148
    v_max_f32 v149, 0, v149
    v_max_f32 v150, 0, v150
    v_mfma_f32_16x16x32_bf16 v[196:199], v[92:95], v[60:63], v[196:199]
    v_max_f32 v151, 0, v151
    v_pk_mul_f32 v[148:149], v[148:149], v[148:149]
    v_pk_mul_f32 v[150:151], v[150:151], v[150:151]
    v_mfma_f32_16x16x32_bf16 v[200:203], v[92:95], v[64:67], v[200:203]
    v_cvt_pk_bf16_f32 v120, v148, v149
    v_cvt_pk_bf16_f32 v121, v150, v151
    v_max_f32 v164, 0, v164
    v_mfma_f32_16x16x32_bf16 v[204:207], v[92:95], v[68:71], v[204:207]
    v_max_f32 v165, 0, v165
    v_max_f32 v166, 0, v166
    v_max_f32 v167, 0, v167
    v_mfma_f32_16x16x32_bf16 v[208:211], v[92:95], v[72:75], v[208:211]
    v_pk_mul_f32 v[164:165], v[164:165], v[164:165]
    v_pk_mul_f32 v[166:167], v[166:167], v[166:167]
    v_cvt_pk_bf16_f32 v122, v164, v165
    v_mfma_f32_16x16x32_bf16 v[212:215], v[52:55], v[16:19], v[212:215]
    v_cvt_pk_bf16_f32 v123, v166, v167
    s_add_u32 s27, s26, 32768
    buffer_store_dwordx4 v[120:123], v3, s[32:35], s27 offen offset:0 sc1
    v_max_f32 v152, 0, v152
    v_mfma_f32_16x16x32_bf16 v[216:219], v[52:55], v[20:23], v[216:219]
    v_max_f32 v153, 0, v153
    v_max_f32 v154, 0, v154
    v_max_f32 v155, 0, v155
    v_mfma_f32_16x16x32_bf16 v[220:223], v[52:55], v[24:27], v[220:223]
    v_pk_mul_f32 v[152:153], v[152:153], v[152:153]
    v_pk_mul_f32 v[154:155], v[154:155], v[154:155]
    v_cvt_pk_bf16_f32 v124, v152, v153
    v_mfma_f32_16x16x32_bf16 v[224:227], v[52:55], v[28:31], v[224:227]
    v_cvt_pk_bf16_f32 v125, v154, v155
    v_max_f32 v168, 0, v168
    v_max_f32 v169, 0, v169
    v_mfma_f32_16x16x32_bf16 v[212:215], v[96:99], v[60:63], v[212:215]
    v_max_f32 v170, 0, v170
    v_max_f32 v171, 0, v171
    v_pk_mul_f32 v[168:169], v[168:169], v[168:169]
    v_mfma_f32_16x16x32_bf16 v[216:219], v[96:99], v[64:67], v[216:219]
    v_pk_mul_f32 v[170:171], v[170:171], v[170:171]
    v_cvt_pk_bf16_f32 v126, v168, v169
    v_cvt_pk_bf16_f32 v127, v170, v171
    v_mfma_f32_16x16x32_bf16 v[220:223], v[96:99], v[68:71], v[220:223]
    s_add_u32 s27, s26, 32768
    buffer_store_dwordx4 v[124:127], v3, s[32:35], s27 offen offset:1024 sc1
    v_max_f32 v156, 0, v156
    v_max_f32 v157, 0, v157
    v_mfma_f32_16x16x32_bf16 v[224:227], v[96:99], v[72:75], v[224:227]
    v_max_f32 v158, 0, v158
    v_max_f32 v159, 0, v159
    v_pk_mul_f32 v[156:157], v[156:157], v[156:157]
    v_mfma_f32_16x16x32_bf16 v[228:231], v[56:59], v[16:19], v[228:231]
    v_pk_mul_f32 v[158:159], v[158:159], v[158:159]
    v_cvt_pk_bf16_f32 v128, v156, v157
    v_cvt_pk_bf16_f32 v129, v158, v159
    v_mfma_f32_16x16x32_bf16 v[232:235], v[56:59], v[20:23], v[232:235]
    v_max_f32 v172, 0, v172
    v_max_f32 v173, 0, v173
    v_max_f32 v174, 0, v174
    v_mfma_f32_16x16x32_bf16 v[236:239], v[56:59], v[24:27], v[236:239]
    v_max_f32 v175, 0, v175
    v_pk_mul_f32 v[172:173], v[172:173], v[172:173]
    v_pk_mul_f32 v[174:175], v[174:175], v[174:175]
    v_mfma_f32_16x16x32_bf16 v[240:243], v[56:59], v[28:31], v[240:243]
    v_cvt_pk_bf16_f32 v130, v172, v173
    v_cvt_pk_bf16_f32 v131, v174, v175
    s_add_u32 s27, s26, 32768
    buffer_store_dwordx4 v[128:131], v3, s[32:35], s27 offen offset:2048 sc1
    v_mfma_f32_16x16x32_bf16 v[228:231], v[100:103], v[60:63], v[228:231]
    v_max_f32 v160, 0, v160
    v_max_f32 v161, 0, v161
    v_max_f32 v162, 0, v162
    v_mfma_f32_16x16x32_bf16 v[232:235], v[100:103], v[64:67], v[232:235]
    v_max_f32 v163, 0, v163
    v_pk_mul_f32 v[160:161], v[160:161], v[160:161]
    v_pk_mul_f32 v[162:163], v[162:163], v[162:163]
    v_mfma_f32_16x16x32_bf16 v[236:239], v[100:103], v[68:71], v[236:239]
    v_cvt_pk_bf16_f32 v104, v160, v161
    v_cvt_pk_bf16_f32 v105, v162, v163
    v_max_f32 v176, 0, v176
    v_mfma_f32_16x16x32_bf16 v[240:243], v[100:103], v[72:75], v[240:243]
    v_max_f32 v177, 0, v177
    v_max_f32 v178, 0, v178
    v_max_f32 v179, 0, v179
    v_pk_mul_f32 v[176:177], v[176:177], v[176:177]
    v_pk_mul_f32 v[178:179], v[178:179], v[178:179]
    v_cvt_pk_bf16_f32 v106, v176, v177
    v_cvt_pk_bf16_f32 v107, v178, v179
    s_add_u32 s27, s26, 32768
    buffer_store_dwordx4 v[104:107], v3, s[32:35], s27 offen offset:3072 sc1
    v_max_f32 v180, 0, v180
    v_max_f32 v181, 0, v181
    v_max_f32 v182, 0, v182
    v_max_f32 v183, 0, v183
    v_pk_mul_f32 v[180:181], v[180:181], v[180:181]
    v_pk_mul_f32 v[182:183], v[182:183], v[182:183]
    v_cvt_pk_bf16_f32 v108, v180, v181
    v_cvt_pk_bf16_f32 v109, v182, v183
    v_max_f32 v196, 0, v196
    v_max_f32 v197, 0, v197
    v_max_f32 v198, 0, v198
    v_max_f32 v199, 0, v199
    v_pk_mul_f32 v[196:197], v[196:197], v[196:197]
    v_pk_mul_f32 v[198:199], v[198:199], v[198:199]
    v_cvt_pk_bf16_f32 v110, v196, v197
    v_cvt_pk_bf16_f32 v111, v198, v199
    s_add_u32 s27, s26, 40960
    buffer_store_dwordx4 v[108:111], v3, s[32:35], s27 offen offset:0 sc1
    v_max_f32 v184, 0, v184
    v_max_f32 v185, 0, v185
    v_max_f32 v186, 0, v186
    v_max_f32 v187, 0, v187
    v_pk_mul_f32 v[184:185], v[184:185], v[184:185]
    v_pk_mul_f32 v[186:187], v[186:187], v[186:187]
    v_cvt_pk_bf16_f32 v112, v184, v185
    v_cvt_pk_bf16_f32 v113, v186, v187
    v_max_f32 v200, 0, v200
    v_max_f32 v201, 0, v201
    v_max_f32 v202, 0, v202
    v_max_f32 v203, 0, v203
    v_pk_mul_f32 v[200:201], v[200:201], v[200:201]
    v_pk_mul_f32 v[202:203], v[202:203], v[202:203]
    v_cvt_pk_bf16_f32 v114, v200, v201
    v_cvt_pk_bf16_f32 v115, v202, v203
    s_add_u32 s27, s26, 40960
    buffer_store_dwordx4 v[112:115], v3, s[32:35], s27 offen offset:1024 sc1
    v_max_f32 v188, 0, v188
    v_max_f32 v189, 0, v189
    v_max_f32 v190, 0, v190
    v_max_f32 v191, 0, v191
    v_pk_mul_f32 v[188:189], v[188:189], v[188:189]
    v_pk_mul_f32 v[190:191], v[190:191], v[190:191]
    v_cvt_pk_bf16_f32 v116, v188, v189
    v_cvt_pk_bf16_f32 v117, v190, v191
    v_max_f32 v204, 0, v204
    v_max_f32 v205, 0, v205
    v_max_f32 v206, 0, v206
    v_max_f32 v207, 0, v207
    v_pk_mul_f32 v[204:205], v[204:205], v[204:205]
    v_pk_mul_f32 v[206:207], v[206:207], v[206:207]
    v_cvt_pk_bf16_f32 v118, v204, v205
    v_cvt_pk_bf16_f32 v119, v206, v207
    s_add_u32 s27, s26, 40960
    buffer_store_dwordx4 v[116:119], v3, s[32:35], s27 offen offset:2048 sc1
    v_max_f32 v192, 0, v192
    v_max_f32 v193, 0, v193
    v_max_f32 v194, 0, v194
    v_max_f32 v195, 0, v195
    v_pk_mul_f32 v[192:193], v[192:193], v[192:193]
    v_pk_mul_f32 v[194:195], v[194:195], v[194:195]
    v_cvt_pk_bf16_f32 v120, v192, v193
    v_cvt_pk_bf16_f32 v121, v194, v195
    v_max_f32 v208, 0, v208
    v_max_f32 v209, 0, v209
    v_max_f32 v210, 0, v210
    v_max_f32 v211, 0, v211
    v_pk_mul_f32 v[208:209], v[208:209], v[208:209]
    v_pk_mul_f32 v[210:211], v[210:211], v[210:211]
    v_cvt_pk_bf16_f32 v122, v208, v209
    v_cvt_pk_bf16_f32 v123, v210, v211
    s_add_u32 s27, s26, 40960
    buffer_store_dwordx4 v[120:123], v3, s[32:35], s27 offen offset:3072 sc1
    v_max_f32 v212, 0, v212
    v_max_f32 v213, 0, v213
    v_max_f32 v214, 0, v214
    v_max_f32 v215, 0, v215
    v_pk_mul_f32 v[212:213], v[212:213], v[212:213]
    v_pk_mul_f32 v[214:215], v[214:215], v[214:215]
    v_cvt_pk_bf16_f32 v124, v212, v213
    v_cvt_pk_bf16_f32 v125, v214, v215
    v_max_f32 v228, 0, v228
    v_max_f32 v229, 0, v229
    v_max_f32 v230, 0, v230
    v_max_f32 v231, 0, v231
    v_pk_mul_f32 v[228:229], v[228:229], v[228:229]
    v_pk_mul_f32 v[230:231], v[230:231], v[230:231]
    v_cvt_pk_bf16_f32 v126, v228, v229
    v_cvt_pk_bf16_f32 v127, v230, v231
    s_add_u32 s27, s26, 49152
    buffer_store_dwordx4 v[124:127], v3, s[32:35], s27 offen offset:0 sc1
    v_max_f32 v216, 0, v216
    v_max_f32 v217, 0, v217
    v_max_f32 v218, 0, v218
    v_max_f32 v219, 0, v219
    v_pk_mul_f32 v[216:217], v[216:217], v[216:217]
    v_pk_mul_f32 v[218:219], v[218:219], v[218:219]
    v_cvt_pk_bf16_f32 v128, v216, v217
    v_cvt_pk_bf16_f32 v129, v218, v219
    v_max_f32 v232, 0, v232
    v_max_f32 v233, 0, v233
    v_max_f32 v234, 0, v234
    v_max_f32 v235, 0, v235
    v_pk_mul_f32 v[232:233], v[232:233], v[232:233]
    v_pk_mul_f32 v[234:235], v[234:235], v[234:235]
    v_cvt_pk_bf16_f32 v130, v232, v233
    v_cvt_pk_bf16_f32 v131, v234, v235
    s_add_u32 s27, s26, 49152
    buffer_store_dwordx4 v[128:131], v3, s[32:35], s27 offen offset:1024 sc1
    v_max_f32 v220, 0, v220
    v_max_f32 v221, 0, v221
    v_max_f32 v222, 0, v222
    v_max_f32 v223, 0, v223
    v_pk_mul_f32 v[220:221], v[220:221], v[220:221]
    v_pk_mul_f32 v[222:223], v[222:223], v[222:223]
    v_cvt_pk_bf16_f32 v104, v220, v221
    v_cvt_pk_bf16_f32 v105, v222, v223
    v_max_f32 v236, 0, v236
    v_max_f32 v237, 0, v237
    v_max_f32 v238, 0, v238
    v_max_f32 v239, 0, v239
    v_pk_mul_f32 v[236:237], v[236:237], v[236:237]
    v_pk_mul_f32 v[238:239], v[238:239], v[238:239]
    v_cvt_pk_bf16_f32 v106, v236, v237
    v_cvt_pk_bf16_f32 v107, v238, v239
    s_add_u32 s27, s26, 49152
    buffer_store_dwordx4 v[104:107], v3, s[32:35], s27 offen offset:2048 sc1
    v_max_f32 v224, 0, v224
    v_max_f32 v225, 0, v225
    v_max_f32 v226, 0, v226
    v_max_f32 v227, 0, v227
    v_pk_mul_f32 v[224:225], v[224:225], v[224:225]
    v_pk_mul_f32 v[226:227], v[226:227], v[226:227]
    v_cvt_pk_bf16_f32 v108, v224, v225
    v_cvt_pk_bf16_f32 v109, v226, v227
    v_max_f32 v240, 0, v240
    v_max_f32 v241, 0, v241
    v_max_f32 v242, 0, v242
    v_max_f32 v243, 0, v243
    v_pk_mul_f32 v[240:241], v[240:241], v[240:241]
    v_pk_mul_f32 v[242:243], v[242:243], v[242:243]
    v_cvt_pk_bf16_f32 v110, v240, v241
    v_cvt_pk_bf16_f32 v111, v242, v243
    s_add_u32 s27, s26, 49152
    buffer_store_dwordx4 v[108:111], v3, s[32:35], s27 offen offset:3072 sc1
L_epd_g1:
    s_cmp_lg_u32 s60, 0
    s_cbranch_scc1 L_w2g
    s_cmp_lg_u32 s20, 0
    s_cbranch_scc1 L_wt3050d
    s_add_u32 s66, s77, s65
    s_add_u32 s66, s66, 131072
    v_and_b32 v13, 1008, v3
    s_mov_b32 s67, 0x40000
L_wt3050:
    buffer_load_dwordx4 v[8:11], v13, s[32:35], s66 offen sc1
    s_waitcnt vmcnt(0)
    v_xor_b32 v8, s64, v8
    v_xor_b32 v9, s64, v9
    v_xor_b32 v10, s64, v10
    v_xor_b32 v11, s64, v11
    v_or3_b32 v8, v8, v9, v10
    v_or_b32 v12, v8, v11
    v_cmp_ne_u32 vcc, 0, v12
    s_cmp_eq_u64 vcc, 0
    s_cbranch_scc1 L_wt3050d
    s_sub_u32 s67, s67, 1
    s_cmp_lg_u32 s67, 0
    s_cbranch_scc1 L_wt3050
L_wt3050d:
    s_barrier
L_w2g:
    s_add_u32 s66, s78, s65
    s_add_u32 s66, s66, 49152
    v_mov_b32 v12, s64
    v_lshlrev_b32 v13, 10, v2
    s_waitcnt vmcnt(0)
    s_barrier
    s_cmp_lg_u32 s20, 0
    s_cbranch_scc1 L_sg3080
    s_mov_b64 exec, 1
    buffer_store_dword v12, v13, s[32:35], s66 offen sc1
    s_mov_b64 exec, -1
L_sg3080:
    s_load_dwordx4 s[4:7], s[0:1], 80
    s_load_dwordx2 s[14:15], s[0:1], 104
    s_lshr_b32 s46, s17, 3
    s_and_b32 s47, s20, 1
    s_and_b32 s48, s17, 7
    s_lshl_b32 s48, s48, 1
    s_lshr_b32 s23, s20, 1
    s_add_u32 s48, s48, s23
    s_mul_i32 s49, s46, 56
    s_lshl_b32 s44, s20, 12
    s_mul_i32 s21, s16, 917504
    s_lshl_b32 s22, s49, 13
    s_add_u32 s21, s21, s22
    s_add_u32 s21, s21, s63
    s_add_u32 s21, s21, s44
    s_mul_i32 s22, s48, 458752
    s_lshl_b32 s49, s49, 1
    s_add_u32 s49, s49, s47
    s_lshl_b32 s49, s49, 11
    s_add_u32 s22, s22, s49
    s_add_u32 s22, s22, 12582912
    s_waitcnt lgkmcnt(0)
    s_mov_b32 s28, s4
    s_and_b32 s29, s5, 0xffff
    s_mov_b32 s30, 2048
    s_mov_b32 s31, 0x20000
    s_mov_b32 s24, s6
    s_and_b32 s25, s7, 0xffff
    s_mov_b32 s26, 4194304
    s_mov_b32 s27, 0x20000
    v_and_b32 v5, 15, v2
    v_lshlrev_b32 v5, 11, v5
    v_lshrrev_b32 v6, 4, v2
    v_lshlrev_b32 v6, 4, v6
    v_add_u32 v5, v5, v6
    v_add_u32 v4, 4096, v3
    v_add_u32 v7, 8192, v3
    s_lshl_b32 s36, s16, 18
    s_lshl_b32 s37, s46, 17
    s_add_u32 s36, s36, s37
    s_lshl_b32 s37, s48, 1
    s_add_u32 s37, s37, s47
    s_lshl_b32 s37, s37, 6
    s_add_u32 s36, s36, s37
    s_add_u32 s38, s36, s62
    s_mul_i32 s49, s46, 0xfb7e0000
    s_cmp_eq_u32 s60, 0
    s_cselect_b32 s49, s49, 0
    s_cselect_b32 s41, 0x40000000, 0
    s_add_u32 s38, s38, s49
    v_or_b32 v32, s41, v5
    s_lshl_b32 s50, s17, 2
    s_add_u32 s50, s50, s20
    s_lshl_b32 s50, s50, 13
    s_xor_b32 s51, s50, 262144
    s_mul_i32 s49, s16, 917504
    s_add_u32 s49, s49, 41943040
    s_add_u32 s50, s50, s49
    s_add_u32 s51, s51, s49
    v_mov_b32 v102, v3
    v_add_u32 v103, 0x10000, v3
    buffer_load_dwordx4 v[104:107], v3, s[32:35], s22 offen offset:0
    buffer_load_dwordx4 v[108:111], v3, s[32:35], s22 offen offset:1024
    buffer_load_dwordx4 v[112:115], v4, s[32:35], s22 offen offset:0
    buffer_load_dwordx4 v[116:119], v4, s[32:35], s22 offen offset:1024
    s_add_u32 s22, s22, 8192
    buffer_load_dwordx4 v[120:123], v3, s[32:35], s22 offen offset:0
    buffer_load_dwordx4 v[124:127], v3, s[32:35], s22 offen offset:1024
    buffer_load_dwordx4 v[128:131], v4, s[32:35], s22 offen offset:0
    buffer_load_dwordx4 v[132:135], v4, s[32:35], s22 offen offset:1024
    s_add_u32 s22, s22, 8192
    buffer_load_dwordx4 v[136:139], v3, s[32:35], s22 offen offset:0
    buffer_load_dwordx4 v[140:143], v3, s[32:35], s22 offen offset:1024
    buffer_load_dwordx4 v[144:147], v4, s[32:35], s22 offen offset:0
    buffer_load_dwordx4 v[148:151], v4, s[32:35], s22 offen offset:1024
    s_add_u32 s22, s22, 8192
    s_cmp_lg_u32 s20, 0
    s_cbranch_scc1 L_wt3162d
    s_add_u32 s66, s71, s65
    s_add_u32 s66, s66, 49152
    v_and_b32 v13, 16, v3
    s_mov_b32 s67, 0x40000
L_wt3162:
    buffer_load_dwordx4 v[8:11], v13, s[32:35], s66 offen sc1
    s_waitcnt vmcnt(0)
    v_xor_b32 v8, s64, v8
    v_xor_b32 v9, s64, v9
    v_xor_b32 v10, s64, v10
    v_xor_b32 v11, s64, v11
    v_or3_b32 v8, v8, v9, v10
    v_or_b32 v12, v8, v11
    v_cmp_ne_u32 vcc, 0, v12
    s_cmp_eq_u64 vcc, 0
    s_cbranch_scc1 L_wt3162d
    s_sub_u32 s67, s67, 1
    s_cmp_lg_u32 s67, 0
    s_cbranch_scc1 L_wt3162
L_wt3162d:
    s_barrier
    s_add_u32 m0, s44, 0
    s_nop 0
    buffer_load_dwordx4 v3, s[32:35], s21 offen offset:0 lds
    buffer_load_dwordx4 v3, s[32:35], s21 offen offset:1024 lds
    buffer_load_dwordx4 v3, s[32:35], s21 offen offset:2048 lds
    buffer_load_dwordx4 v3, s[32:35], s21 offen offset:3072 lds
    s_add_u32 s21, s21, 16384
    s_add_u32 m0, s44, 16384
    s_nop 0
    buffer_load_dwordx4 v3, s[32:35], s21 offen offset:0 lds
    buffer_load_dwordx4 v3, s[32:35], s21 offen offset:1024 lds
    buffer_load_dwordx4 v3, s[32:35], s21 offen offset:2048 lds
    buffer_load_dwordx4 v3, s[32:35], s21 offen offset:3072 lds
    s_add_u32 s21, s21, 16384
    s_add_u32 m0, s44, 32768
    s_nop 0
    buffer_load_dwordx4 v3, s[32:35], s21 offen offset:0 lds
    buffer_load_dwordx4 v3, s[32:35], s21 offen offset:1024 lds
    buffer_load_dwordx4 v3, s[32:35], s21 offen offset:2048 lds
    buffer_load_dwordx4 v3, s[32:35], s21 offen offset:3072 lds
    s_add_u32 s21, s21, 16384
    s_waitcnt vmcnt(4)
    s_barrier
    ds_read_b128 v[36:39], v102 offset:0
    ds_read_b128 v[40:43], v102 offset:1024
    ds_read_b128 v[44:47], v102 offset:2048
    ds_read_b128 v[48:51], v102 offset:3072
    ds_read_b128 v[52:55], v102 offset:4096
    ds_read_b128 v[56:59], v102 offset:5120
    ds_read_b128 v[60:63], v102 offset:6144
    ds_read_b128 v[64:67], v102 offset:7168
    s_mov_b32 s39, 3
L_cl_g2:
    s_waitcnt lgkmcnt(0)
    v_mfma_f32_16x16x32_bf16 a[0:3], v[104:107], v[36:39], a[0:3]
    ds_read_b128 v[68:71], v102 offset:8192
    ds_read_b128 v[72:75], v102 offset:9216
    v_mfma_f32_16x16x32_bf16 a[4:7], v[108:111], v[36:39], a[4:7]
    ds_read_b128 v[76:79], v102 offset:10240
    ds_read_b128 v[80:83], v102 offset:11264
    v_mfma_f32_16x16x32_bf16 a[8:11], v[104:107], v[40:43], a[8:11]
    ds_read_b128 v[84:87], v102 offset:12288
    ds_read_b128 v[88:91], v102 offset:13312
    v_mfma_f32_16x16x32_bf16 a[12:15], v[108:111], v[40:43], a[12:15]
    ds_read_b128 v[92:95], v102 offset:14336
    ds_read_b128 v[96:99], v102 offset:15360
    v_mfma_f32_16x16x32_bf16 a[16:19], v[104:107], v[44:47], a[16:19]
    v_mfma_f32_16x16x32_bf16 a[20:23], v[108:111], v[44:47], a[20:23]
    buffer_load_dwordx4 v[152:155], v3, s[32:35], s22 offen offset:0
    v_mfma_f32_16x16x32_bf16 a[24:27], v[104:107], v[48:51], a[24:27]
    v_mfma_f32_16x16x32_bf16 a[28:31], v[108:111], v[48:51], a[28:31]
    buffer_load_dwordx4 v[156:159], v3, s[32:35], s22 offen offset:1024
    v_mfma_f32_16x16x32_bf16 a[32:35], v[104:107], v[52:55], a[32:35]
    v_mfma_f32_16x16x32_bf16 a[36:39], v[108:111], v[52:55], a[36:39]
    buffer_load_dwordx4 v[160:163], v4, s[32:35], s22 offen offset:0
    v_mfma_f32_16x16x32_bf16 a[40:43], v[104:107], v[56:59], a[40:43]
    v_mfma_f32_16x16x32_bf16 a[44:47], v[108:111], v[56:59], a[44:47]
    buffer_load_dwordx4 v[164:167], v4, s[32:35], s22 offen offset:1024
    s_add_u32 s22, s22, 8192
    v_mfma_f32_16x16x32_bf16 a[48:51], v[104:107], v[60:63], a[48:51]
    v_mfma_f32_16x16x32_bf16 a[52:55], v[108:111], v[60:63], a[52:55]
    s_waitcnt vmcnt(12)
    s_barrier
    v_mfma_f32_16x16x32_bf16 a[56:59], v[104:107], v[64:67], a[56:59]
    v_mfma_f32_16x16x32_bf16 a[60:63], v[108:111], v[64:67], a[60:63]
    s_waitcnt lgkmcnt(0)
    v_mfma_f32_16x16x32_bf16 a[0:3], v[112:115], v[68:71], a[0:3]
    ds_read_b128 v[36:39], v102 offset:16384
    ds_read_b128 v[40:43], v102 offset:17408
    v_mfma_f32_16x16x32_bf16 a[4:7], v[116:119], v[68:71], a[4:7]
    ds_read_b128 v[44:47], v102 offset:18432
    ds_read_b128 v[48:51], v102 offset:19456
    v_mfma_f32_16x16x32_bf16 a[8:11], v[112:115], v[72:75], a[8:11]
    ds_read_b128 v[52:55], v102 offset:20480
    ds_read_b128 v[56:59], v102 offset:21504
    v_mfma_f32_16x16x32_bf16 a[12:15], v[116:119], v[72:75], a[12:15]
    ds_read_b128 v[60:63], v102 offset:22528
    ds_read_b128 v[64:67], v102 offset:23552
    v_mfma_f32_16x16x32_bf16 a[16:19], v[112:115], v[76:79], a[16:19]
    v_mfma_f32_16x16x32_bf16 a[20:23], v[116:119], v[76:79], a[20:23]
    s_add_u32 m0, s44, 49152
    s_nop 0
    buffer_load_dwordx4 v3, s[32:35], s21 offen offset:0 lds
    v_mfma_f32_16x16x32_bf16 a[24:27], v[112:115], v[80:83], a[24:27]
    v_mfma_f32_16x16x32_bf16 a[28:31], v[116:119], v[80:83], a[28:31]
    buffer_load_dwordx4 v3, s[32:35], s21 offen offset:1024 lds
    v_mfma_f32_16x16x32_bf16 a[32:35], v[112:115], v[84:87], a[32:35]
    v_mfma_f32_16x16x32_bf16 a[36:39], v[116:119], v[84:87], a[36:39]
    buffer_load_dwordx4 v3, s[32:35], s21 offen offset:2048 lds
    v_mfma_f32_16x16x32_bf16 a[40:43], v[112:115], v[88:91], a[40:43]
    v_mfma_f32_16x16x32_bf16 a[44:47], v[116:119], v[88:91], a[44:47]
    buffer_load_dwordx4 v3, s[32:35], s21 offen offset:3072 lds
    s_add_u32 s21, s21, 16384
    v_mfma_f32_16x16x32_bf16 a[48:51], v[112:115], v[92:95], a[48:51]
    v_mfma_f32_16x16x32_bf16 a[52:55], v[116:119], v[92:95], a[52:55]
    v_mfma_f32_16x16x32_bf16 a[56:59], v[112:115], v[96:99], a[56:59]
    v_mfma_f32_16x16x32_bf16 a[60:63], v[116:119], v[96:99], a[60:63]
    s_waitcnt lgkmcnt(0)
    v_mfma_f32_16x16x32_bf16 a[0:3], v[120:123], v[36:39], a[0:3]
    ds_read_b128 v[68:71], v102 offset:24576
    ds_read_b128 v[72:75], v102 offset:25600
    v_mfma_f32_16x16x32_bf16 a[4:7], v[124:127], v[36:39], a[4:7]
    ds_read_b128 v[76:79], v102 offset:26624
    ds_read_b128 v[80:83], v102 offset:27648
    v_mfma_f32_16x16x32_bf16 a[8:11], v[120:123], v[40:43], a[8:11]
    ds_read_b128 v[84:87], v102 offset:28672
    ds_read_b128 v[88:91], v102 offset:29696
    v_mfma_f32_16x16x32_bf16 a[12:15], v[124:127], v[40:43], a[12:15]
    ds_read_b128 v[92:95], v102 offset:30720
    ds_read_b128 v[96:99], v102 offset:31744
    v_mfma_f32_16x16x32_bf16 a[16:19], v[120:123], v[44:47], a[16:19]
    v_mfma_f32_16x16x32_bf16 a[20:23], v[124:127], v[44:47], a[20:23]
    buffer_load_dwordx4 v[168:171], v3, s[32:35], s22 offen offset:0
    v_mfma_f32_16x16x32_bf16 a[24:27], v[120:123], v[48:51], a[24:27]
    v_mfma_f32_16x16x32_bf16 a[28:31], v[124:127], v[48:51], a[28:31]
    buffer_load_dwordx4 v[172:175], v3, s[32:35], s22 offen offset:1024
    v_mfma_f32_16x16x32_bf16 a[32:35], v[120:123], v[52:55], a[32:35]
    v_mfma_f32_16x16x32_bf16 a[36:39], v[124:127], v[52:55], a[36:39]
    buffer_load_dwordx4 v[176:179], v4, s[32:35], s22 offen offset:0
    v_mfma_f32_16x16x32_bf16 a[40:43], v[120:123], v[56:59], a[40:43]
    v_mfma_f32_16x16x32_bf16 a[44:47], v[124:127], v[56:59], a[44:47]
    buffer_load_dwordx4 v[180:183], v4, s[32:35], s22 offen offset:1024
    s_add_u32 s22, s22, 8192
    v_mfma_f32_16x16x32_bf16 a[48:51], v[120:123], v[60:63], a[48:51]
    v_mfma_f32_16x16x32_bf16 a[52:55], v[124:127], v[60:63], a[52:55]
    s_waitcnt vmcnt(12)
    s_barrier
    v_mfma_f32_16x16x32_bf16 a[56:59], v[120:123], v[64:67], a[56:59]
    v_mfma_f32_16x16x32_bf16 a[60:63], v[124:127], v[64:67], a[60:63]
    s_waitcnt lgkmcnt(0)
    v_mfma_f32_16x16x32_bf16 a[0:3], v[128:131], v[68:71], a[0:3]
    ds_read_b128 v[36:39], v102 offset:32768
    ds_read_b128 v[40:43], v102 offset:33792
    v_mfma_f32_16x16x32_bf16 a[4:7], v[132:135], v[68:71], a[4:7]
    ds_read_b128 v[44:47], v102 offset:34816
    ds_read_b128 v[48:51], v102 offset:35840
    v_mfma_f32_16x16x32_bf16 a[8:11], v[128:131], v[72:75], a[8:11]
    ds_read_b128 v[52:55], v102 offset:36864
    ds_read_b128 v[56:59], v102 offset:37888
    v_mfma_f32_16x16x32_bf16 a[12:15], v[132:135], v[72:75], a[12:15]
    ds_read_b128 v[60:63], v102 offset:38912
    ds_read_b128 v[64:67], v102 offset:39936
    v_mfma_f32_16x16x32_bf16 a[16:19], v[128:131], v[76:79], a[16:19]
    v_mfma_f32_16x16x32_bf16 a[20:23], v[132:135], v[76:79], a[20:23]
    s_add_u32 m0, s44, 65536
    s_nop 0
    buffer_load_dwordx4 v3, s[32:35], s21 offen offset:0 lds
    v_mfma_f32_16x16x32_bf16 a[24:27], v[128:131], v[80:83], a[24:27]
    v_mfma_f32_16x16x32_bf16 a[28:31], v[132:135], v[80:83], a[28:31]
    buffer_load_dwordx4 v3, s[32:35], s21 offen offset:1024 lds
    v_mfma_f32_16x16x32_bf16 a[32:35], v[128:131], v[84:87], a[32:35]
    v_mfma_f32_16x16x32_bf16 a[36:39], v[132:135], v[84:87], a[36:39]
    buffer_load_dwordx4 v3, s[32:35], s21 offen offset:2048 lds
    v_mfma_f32_16x16x32_bf16 a[40:43], v[128:131], v[88:91], a[40:43]
    v_mfma_f32_16x16x32_bf16 a[44:47], v[132:135], v[88:91], a[44:47]
    buffer_load_dwordx4 v3, s[32:35], s21 offen offset:3072 lds
    s_add_u32 s21, s21, 16384
    v_mfma_f32_16x16x32_bf16 a[48:51], v[128:131], v[92:95], a[48:51]
    v_mfma_f32_16x16x32_bf16 a[52:55], v[132:135], v[92:95], a[52:55]
    v_mfma_f32_16x16x32_bf16 a[56:59], v[128:131], v[96:99], a[56:59]
    v_mfma_f32_16x16x32_bf16 a[60:63], v[132:135], v[96:99], a[60:63]
    s_waitcnt lgkmcnt(0)
    v_mfma_f32_16x16x32_bf16 a[0:3], v[136:139], v[36:39], a[0:3]
    ds_read_b128 v[68:71], v102 offset:40960
    ds_read_b128 v[72:75], v102 offset:41984
    v_mfma_f32_16x16x32_bf16 a[4:7], v[140:143], v[36:39], a[4:7]
    ds_read_b128 v[76:79], v102 offset:43008
    ds_read_b128 v[80:83], v102 offset:44032
    v_mfma_f32_16x16x32_bf16 a[8:11], v[136:139], v[40:43], a[8:11]
    ds_read_b128 v[84:87], v102 offset:45056
    ds_read_b128 v[88:91], v102 offset:46080
    v_mfma_f32_16x16x32_bf16 a[12:15], v[140:143], v[40:43], a[12:15]
    ds_read_b128 v[92:95], v102 offset:47104
    ds_read_b128 v[96:99], v102 offset:48128
    v_mfma_f32_16x16x32_bf16 a[16:19], v[136:139], v[44:47], a[16:19]
    v_mfma_f32_16x16x32_bf16 a[20:23], v[140:143], v[44:47], a[20:23]
    buffer_load_dwordx4 v[184:187], v3, s[32:35], s22 offen offset:0
    v_mfma_f32_16x16x32_bf16 a[24:27], v[136:139], v[48:51], a[24:27]
    v_mfma_f32_16x16x32_bf16 a[28:31], v[140:143], v[48:51], a[28:31]
    buffer_load_dwordx4 v[188:191], v3, s[32:35], s22 offen offset:1024
    v_mfma_f32_16x16x32_bf16 a[32:35], v[136:139], v[52:55], a[32:35]
    v_mfma_f32_16x16x32_bf16 a[36:39], v[140:143], v[52:55], a[36:39]
    buffer_load_dwordx4 v[192:195], v4, s[32:35], s22 offen offset:0
    v_mfma_f32_16x16x32_bf16 a[40:43], v[136:139], v[56:59], a[40:43]
    v_mfma_f32_16x16x32_bf16 a[44:47], v[140:143], v[56:59], a[44:47]
    buffer_load_dwordx4 v[196:199], v4, s[32:35], s22 offen offset:1024
    s_add_u32 s22, s22, 8192
    v_mfma_f32_16x16x32_bf16 a[48:51], v[136:139], v[60:63], a[48:51]
    v_mfma_f32_16x16x32_bf16 a[52:55], v[140:143], v[60:63], a[52:55]
    s_waitcnt vmcnt(12)
    s_barrier
    v_mfma_f32_16x16x32_bf16 a[56:59], v[136:139], v[64:67], a[56:59]
    v_mfma_f32_16x16x32_bf16 a[60:63], v[140:143], v[64:67], a[60:63]
    s_waitcnt lgkmcnt(0)
    v_mfma_f32_16x16x32_bf16 a[0:3], v[144:147], v[68:71], a[0:3]
    ds_read_b128 v[36:39], v102 offset:49152
    ds_read_b128 v[40:43], v102 offset:50176
    v_mfma_f32_16x16x32_bf16 a[4:7], v[148:151], v[68:71], a[4:7]
    ds_read_b128 v[44:47], v102 offset:51200
    ds_read_b128 v[48:51], v102 offset:52224
    v_mfma_f32_16x16x32_bf16 a[8:11], v[144:147], v[72:75], a[8:11]
    ds_read_b128 v[52:55], v102 offset:53248
    ds_read_b128 v[56:59], v102 offset:54272
    v_mfma_f32_16x16x32_bf16 a[12:15], v[148:151], v[72:75], a[12:15]
    ds_read_b128 v[60:63], v102 offset:55296
    ds_read_b128 v[64:67], v102 offset:56320
    v_mfma_f32_16x16x32_bf16 a[16:19], v[144:147], v[76:79], a[16:19]
    v_mfma_f32_16x16x32_bf16 a[20:23], v[148:151], v[76:79], a[20:23]
    s_add_u32 m0, s44, 81920
    s_nop 0
    buffer_load_dwordx4 v3, s[32:35], s21 offen offset:0 lds
    v_mfma_f32_16x16x32_bf16 a[24:27], v[144:147], v[80:83], a[24:27]
    v_mfma_f32_16x16x32_bf16 a[28:31], v[148:151], v[80:83], a[28:31]
    buffer_load_dwordx4 v3, s[32:35], s21 offen offset:1024 lds
    v_mfma_f32_16x16x32_bf16 a[32:35], v[144:147], v[84:87], a[32:35]
    v_mfma_f32_16x16x32_bf16 a[36:39], v[148:151], v[84:87], a[36:39]
    buffer_load_dwordx4 v3, s[32:35], s21 offen offset:2048 lds
    v_mfma_f32_16x16x32_bf16 a[40:43], v[144:147], v[88:91], a[40:43]
    v_mfma_f32_16x16x32_bf16 a[44:47], v[148:151], v[88:91], a[44:47]
    buffer_load_dwordx4 v3, s[32:35], s21 offen offset:3072 lds
    s_add_u32 s21, s21, 16384
    v_mfma_f32_16x16x32_bf16 a[48:51], v[144:147], v[92:95], a[48:51]
    v_mfma_f32_16x16x32_bf16 a[52:55], v[148:151], v[92:95], a[52:55]
    v_mfma_f32_16x16x32_bf16 a[56:59], v[144:147], v[96:99], a[56:59]
    v_mfma_f32_16x16x32_bf16 a[60:63], v[148:151], v[96:99], a[60:63]
    s_waitcnt lgkmcnt(0)
    v_mfma_f32_16x16x32_bf16 a[0:3], v[152:155], v[36:39], a[0:3]
    ds_read_b128 v[68:71], v102 offset:57344
    ds_read_b128 v[72:75], v102 offset:58368
    v_mfma_f32_16x16x32_bf16 a[4:7], v[156:159], v[36:39], a[4:7]
    ds_read_b128 v[76:79], v102 offset:59392
    ds_read_b128 v[80:83], v102 offset:60416
    v_mfma_f32_16x16x32_bf16 a[8:11], v[152:155], v[40:43], a[8:11]
    ds_read_b128 v[84:87], v102 offset:61440
    ds_read_b128 v[88:91], v102 offset:62464
    v_mfma_f32_16x16x32_bf16 a[12:15], v[156:159], v[40:43], a[12:15]
    ds_read_b128 v[92:95], v102 offset:63488
    ds_read_b128 v[96:99], v102 offset:64512
    v_mfma_f32_16x16x32_bf16 a[16:19], v[152:155], v[44:47], a[16:19]
    v_mfma_f32_16x16x32_bf16 a[20:23], v[156:159], v[44:47], a[20:23]
    buffer_load_dwordx4 v[200:203], v3, s[32:35], s22 offen offset:0
    v_mfma_f32_16x16x32_bf16 a[24:27], v[152:155], v[48:51], a[24:27]
    v_mfma_f32_16x16x32_bf16 a[28:31], v[156:159], v[48:51], a[28:31]
    buffer_load_dwordx4 v[204:207], v3, s[32:35], s22 offen offset:1024
    v_mfma_f32_16x16x32_bf16 a[32:35], v[152:155], v[52:55], a[32:35]
    v_mfma_f32_16x16x32_bf16 a[36:39], v[156:159], v[52:55], a[36:39]
    buffer_load_dwordx4 v[208:211], v4, s[32:35], s22 offen offset:0
    v_mfma_f32_16x16x32_bf16 a[40:43], v[152:155], v[56:59], a[40:43]
    v_mfma_f32_16x16x32_bf16 a[44:47], v[156:159], v[56:59], a[44:47]
    buffer_load_dwordx4 v[212:215], v4, s[32:35], s22 offen offset:1024
    s_add_u32 s22, s22, 8192
    v_mfma_f32_16x16x32_bf16 a[48:51], v[152:155], v[60:63], a[48:51]
    v_mfma_f32_16x16x32_bf16 a[52:55], v[156:159], v[60:63], a[52:55]
    s_waitcnt vmcnt(12)
    s_barrier
    v_mfma_f32_16x16x32_bf16 a[56:59], v[152:155], v[64:67], a[56:59]
    v_mfma_f32_16x16x32_bf16 a[60:63], v[156:159], v[64:67], a[60:63]
    s_waitcnt lgkmcnt(0)
    v_mfma_f32_16x16x32_bf16 a[0:3], v[160:163], v[68:71], a[0:3]
    ds_read_b128 v[36:39], v103 offset:0
    ds_read_b128 v[40:43], v103 offset:1024
    v_mfma_f32_16x16x32_bf16 a[4:7], v[164:167], v[68:71], a[4:7]
    ds_read_b128 v[44:47], v103 offset:2048
    ds_read_b128 v[48:51], v103 offset:3072
    v_mfma_f32_16x16x32_bf16 a[8:11], v[160:163], v[72:75], a[8:11]
    ds_read_b128 v[52:55], v103 offset:4096
    ds_read_b128 v[56:59], v103 offset:5120
    v_mfma_f32_16x16x32_bf16 a[12:15], v[164:167], v[72:75], a[12:15]
    ds_read_b128 v[60:63], v103 offset:6144
    ds_read_b128 v[64:67], v103 offset:7168
    v_mfma_f32_16x16x32_bf16 a[16:19], v[160:163], v[76:79], a[16:19]
    v_mfma_f32_16x16x32_bf16 a[20:23], v[164:167], v[76:79], a[20:23]
    s_add_u32 m0, s44, 98304
    s_nop 0
    buffer_load_dwordx4 v3, s[32:35], s21 offen offset:0 lds
    v_mfma_f32_16x16x32_bf16 a[24:27], v[160:163], v[80:83], a[24:27]
    v_mfma_f32_16x16x32_bf16 a[28:31], v[164:167], v[80:83], a[28:31]
    buffer_load_dwordx4 v3, s[32:35], s21 offen offset:1024 lds
    v_mfma_f32_16x16x32_bf16 a[32:35], v[160:163], v[84:87], a[32:35]
    v_mfma_f32_16x16x32_bf16 a[36:39], v[164:167], v[84:87], a[36:39]
    buffer_load_dwordx4 v3, s[32:35], s21 offen offset:2048 lds
    v_mfma_f32_16x16x32_bf16 a[40:43], v[160:163], v[88:91], a[40:43]
    v_mfma_f32_16x16x32_bf16 a[44:47], v[164:167], v[88:91], a[44:47]
    buffer_load_dwordx4 v3, s[32:35], s21 offen offset:3072 lds
    s_add_u32 s21, s21, 16384
    v_mfma_f32_16x16x32_bf16 a[48:51], v[160:163], v[92:95], a[48:51]
    v_mfma_f32_16x16x32_bf16 a[52:55], v[164:167], v[92:95], a[52:55]
    v_mfma_f32_16x16x32_bf16 a[56:59], v[160:163], v[96:99], a[56:59]
    v_mfma_f32_16x16x32_bf16 a[60:63], v[164:167], v[96:99], a[60:63]
    s_waitcnt lgkmcnt(0)
    v_mfma_f32_16x16x32_bf16 a[0:3], v[168:171], v[36:39], a[0:3]
    ds_read_b128 v[68:71], v103 offset:8192
    ds_read_b128 v[72:75], v103 offset:9216
    v_mfma_f32_16x16x32_bf16 a[4:7], v[172:175], v[36:39], a[4:7]
    ds_read_b128 v[76:79], v103 offset:10240
    ds_read_b128 v[80:83], v103 offset:11264
    v_mfma_f32_16x16x32_bf16 a[8:11], v[168:171], v[40:43], a[8:11]
    ds_read_b128 v[84:87], v103 offset:12288
    ds_read_b128 v[88:91], v103 offset:13312
    v_mfma_f32_16x16x32_bf16 a[12:15], v[172:175], v[40:43], a[12:15]
    ds_read_b128 v[92:95], v103 offset:14336
    ds_read_b128 v[96:99], v103 offset:15360
    v_mfma_f32_16x16x32_bf16 a[16:19], v[168:171], v[44:47], a[16:19]
    v_mfma_f32_16x16x32_bf16 a[20:23], v[172:175], v[44:47], a[20:23]
    buffer_load_dwordx4 v[216:219], v3, s[32:35], s22 offen offset:0
    v_mfma_f32_16x16x32_bf16 a[24:27], v[168:171], v[48:51], a[24:27]
    v_mfma_f32_16x16x32_bf16 a[28:31], v[172:175], v[48:51], a[28:31]
    buffer_load_dwordx4 v[220:223], v3, s[32:35], s22 offen offset:1024
    v_mfma_f32_16x16x32_bf16 a[32:35], v[168:171], v[52:55], a[32:35]
    v_mfma_f32_16x16x32_bf16 a[36:39], v[172:175], v[52:55], a[36:39]
    buffer_load_dwordx4 v[224:227], v4, s[32:35], s22 offen offset:0
    v_mfma_f32_16x16x32_bf16 a[40:43], v[168:171], v[56:59], a[40:43]
    v_mfma_f32_16x16x32_bf16 a[44:47], v[172:175], v[56:59], a[44:47]
    buffer_load_dwordx4 v[228:231], v4, s[32:35], s22 offen offset:1024
    s_add_u32 s22, s22, 8192
    v_mfma_f32_16x16x32_bf16 a[48:51], v[168:171], v[60:63], a[48:51]
    v_mfma_f32_16x16x32_bf16 a[52:55], v[172:175], v[60:63], a[52:55]
    s_waitcnt vmcnt(12)
    s_barrier
    v_mfma_f32_16x16x32_bf16 a[56:59], v[168:171], v[64:67], a[56:59]
    v_mfma_f32_16x16x32_bf16 a[60:63], v[172:175], v[64:67], a[60:63]
    s_waitcnt lgkmcnt(0)
    v_mfma_f32_16x16x32_bf16 a[0:3], v[176:179], v[68:71], a[0:3]
    ds_read_b128 v[36:39], v103 offset:16384
    ds_read_b128 v[40:43], v103 offset:17408
    v_mfma_f32_16x16x32_bf16 a[4:7], v[180:183], v[68:71], a[4:7]
    ds_read_b128 v[44:47], v103 offset:18432
    ds_read_b128 v[48:51], v103 offset:19456
    v_mfma_f32_16x16x32_bf16 a[8:11], v[176:179], v[72:75], a[8:11]
    ds_read_b128 v[52:55], v103 offset:20480
    ds_read_b128 v[56:59], v103 offset:21504
    v_mfma_f32_16x16x32_bf16 a[12:15], v[180:183], v[72:75], a[12:15]
    ds_read_b128 v[60:63], v103 offset:22528
    ds_read_b128 v[64:67], v103 offset:23552
    v_mfma_f32_16x16x32_bf16 a[16:19], v[176:179], v[76:79], a[16:19]
    v_mfma_f32_16x16x32_bf16 a[20:23], v[180:183], v[76:79], a[20:23]
    s_add_u32 m0, s44, 114688
    s_nop 0
    buffer_load_dwordx4 v3, s[32:35], s21 offen offset:0 lds
    v_mfma_f32_16x16x32_bf16 a[24:27], v[176:179], v[80:83], a[24:27]
    v_mfma_f32_16x16x32_bf16 a[28:31], v[180:183], v[80:83], a[28:31]
    buffer_load_dwordx4 v3, s[32:35], s21 offen offset:1024 lds
    v_mfma_f32_16x16x32_bf16 a[32:35], v[176:179], v[84:87], a[32:35]
    v_mfma_f32_16x16x32_bf16 a[36:39], v[180:183], v[84:87], a[36:39]
    buffer_load_dwordx4 v3, s[32:35], s21 offen offset:2048 lds
    v_mfma_f32_16x16x32_bf16 a[40:43], v[176:179], v[88:91], a[40:43]
    v_mfma_f32_16x16x32_bf16 a[44:47], v[180:183], v[88:91], a[44:47]
    buffer_load_dwordx4 v3, s[32:35], s21 offen offset:3072 lds
    s_add_u32 s21, s21, 16384
    v_mfma_f32_16x16x32_bf16 a[48:51], v[176:179], v[92:95], a[48:51]
    v_mfma_f32_16x16x32_bf16 a[52:55], v[180:183], v[92:95], a[52:55]
    v_mfma_f32_16x16x32_bf16 a[56:59], v[176:179], v[96:99], a[56:59]
    v_mfma_f32_16x16x32_bf16 a[60:63], v[180:183], v[96:99], a[60:63]
    s_waitcnt lgkmcnt(0)
    v_mfma_f32_16x16x32_bf16 a[0:3], v[184:187], v[36:39], a[0:3]
    ds_read_b128 v[68:71], v103 offset:24576
    ds_read_b128 v[72:75], v103 offset:25600
    v_mfma_f32_16x16x32_bf16 a[4:7], v[188:191], v[36:39], a[4:7]
    ds_read_b128 v[76:79], v103 offset:26624
    ds_read_b128 v[80:83], v103 offset:27648
    v_mfma_f32_16x16x32_bf16 a[8:11], v[184:187], v[40:43], a[8:11]
    ds_read_b128 v[84:87], v103 offset:28672
    ds_read_b128 v[88:91], v103 offset:29696
    v_mfma_f32_16x16x32_bf16 a[12:15], v[188:191], v[40:43], a[12:15]
    ds_read_b128 v[92:95], v103 offset:30720
    ds_read_b128 v[96:99], v103 offset:31744
    v_mfma_f32_16x16x32_bf16 a[16:19], v[184:187], v[44:47], a[16:19]
    v_mfma_f32_16x16x32_bf16 a[20:23], v[188:191], v[44:47], a[20:23]
    buffer_load_dwordx4 v[104:107], v3, s[32:35], s22 offen offset:0
    v_mfma_f32_16x16x32_bf16 a[24:27], v[184:187], v[48:51], a[24:27]
    v_mfma_f32_16x16x32_bf16 a[28:31], v[188:191], v[48:51], a[28:31]
    buffer_load_dwordx4 v[108:111], v3, s[32:35], s22 offen offset:1024
    v_mfma_f32_16x16x32_bf16 a[32:35], v[184:187], v[52:55], a[32:35]
    v_mfma_f32_16x16x32_bf16 a[36:39], v[188:191], v[52:55], a[36:39]
    buffer_load_dwordx4 v[112:115], v4, s[32:35], s22 offen offset:0
    v_mfma_f32_16x16x32_bf16 a[40:43], v[184:187], v[56:59], a[40:43]
    v_mfma_f32_16x16x32_bf16 a[44:47], v[188:191], v[56:59], a[44:47]
    buffer_load_dwordx4 v[116:119], v4, s[32:35], s22 offen offset:1024
    s_add_u32 s22, s22, 8192
    v_mfma_f32_16x16x32_bf16 a[48:51], v[184:187], v[60:63], a[48:51]
    v_mfma_f32_16x16x32_bf16 a[52:55], v[188:191], v[60:63], a[52:55]
    s_waitcnt vmcnt(12)
    s_barrier
    v_mfma_f32_16x16x32_bf16 a[56:59], v[184:187], v[64:67], a[56:59]
    v_mfma_f32_16x16x32_bf16 a[60:63], v[188:191], v[64:67], a[60:63]
    s_waitcnt lgkmcnt(0)
    v_mfma_f32_16x16x32_bf16 a[0:3], v[192:195], v[68:71], a[0:3]
    ds_read_b128 v[36:39], v103 offset:32768
    ds_read_b128 v[40:43], v103 offset:33792
    v_mfma_f32_16x16x32_bf16 a[4:7], v[196:199], v[68:71], a[4:7]
    ds_read_b128 v[44:47], v103 offset:34816
    ds_read_b128 v[48:51], v103 offset:35840
    v_mfma_f32_16x16x32_bf16 a[8:11], v[192:195], v[72:75], a[8:11]
    ds_read_b128 v[52:55], v103 offset:36864
    ds_read_b128 v[56:59], v103 offset:37888
    v_mfma_f32_16x16x32_bf16 a[12:15], v[196:199], v[72:75], a[12:15]
    ds_read_b128 v[60:63], v103 offset:38912
    ds_read_b128 v[64:67], v103 offset:39936
    v_mfma_f32_16x16x32_bf16 a[16:19], v[192:195], v[76:79], a[16:19]
    v_mfma_f32_16x16x32_bf16 a[20:23], v[196:199], v[76:79], a[20:23]
    s_add_u32 m0, s44, 0
    s_nop 0
    buffer_load_dwordx4 v3, s[32:35], s21 offen offset:0 lds
    v_mfma_f32_16x16x32_bf16 a[24:27], v[192:195], v[80:83], a[24:27]
    v_mfma_f32_16x16x32_bf16 a[28:31], v[196:199], v[80:83], a[28:31]
    buffer_load_dwordx4 v3, s[32:35], s21 offen offset:1024 lds
    v_mfma_f32_16x16x32_bf16 a[32:35], v[192:195], v[84:87], a[32:35]
    v_mfma_f32_16x16x32_bf16 a[36:39], v[196:199], v[84:87], a[36:39]
    buffer_load_dwordx4 v3, s[32:35], s21 offen offset:2048 lds
    v_mfma_f32_16x16x32_bf16 a[40:43], v[192:195], v[88:91], a[40:43]
    v_mfma_f32_16x16x32_bf16 a[44:47], v[196:199], v[88:91], a[44:47]
    buffer_load_dwordx4 v3, s[32:35], s21 offen offset:3072 lds
    s_add_u32 s21, s21, 16384
    v_mfma_f32_16x16x32_bf16 a[48:51], v[192:195], v[92:95], a[48:51]
    v_mfma_f32_16x16x32_bf16 a[52:55], v[196:199], v[92:95], a[52:55]
    v_mfma_f32_16x16x32_bf16 a[56:59], v[192:195], v[96:99], a[56:59]
    v_mfma_f32_16x16x32_bf16 a[60:63], v[196:199], v[96:99], a[60:63]
    s_waitcnt lgkmcnt(0)
    v_mfma_f32_16x16x32_bf16 a[0:3], v[200:203], v[36:39], a[0:3]
    ds_read_b128 v[68:71], v103 offset:40960
    ds_read_b128 v[72:75], v103 offset:41984
    v_mfma_f32_16x16x32_bf16 a[4:7], v[204:207], v[36:39], a[4:7]
    ds_read_b128 v[76:79], v103 offset:43008
    ds_read_b128 v[80:83], v103 offset:44032
    v_mfma_f32_16x16x32_bf16 a[8:11], v[200:203], v[40:43], a[8:11]
    ds_read_b128 v[84:87], v103 offset:45056
    ds_read_b128 v[88:91], v103 offset:46080
    v_mfma_f32_16x16x32_bf16 a[12:15], v[204:207], v[40:43], a[12:15]
    ds_read_b128 v[92:95], v103 offset:47104
    ds_read_b128 v[96:99], v103 offset:48128
    v_mfma_f32_16x16x32_bf16 a[16:19], v[200:203], v[44:47], a[16:19]
    v_mfma_f32_16x16x32_bf16 a[20:23], v[204:207], v[44:47], a[20:23]
    buffer_load_dwordx4 v[120:123], v3, s[32:35], s22 offen offset:0
    v_mfma_f32_16x16x32_bf16 a[24:27], v[200:203], v[48:51], a[24:27]
    v_mfma_f32_16x16x32_bf16 a[28:31], v[204:207], v[48:51], a[28:31]
    buffer_load_dwordx4 v[124:127], v3, s[32:35], s22 offen offset:1024
    v_mfma_f32_16x16x32_bf16 a[32:35], v[200:203], v[52:55], a[32:35]
    v_mfma_f32_16x16x32_bf16 a[36:39], v[204:207], v[52:55], a[36:39]
    buffer_load_dwordx4 v[128:131], v4, s[32:35], s22 offen offset:0
    v_mfma_f32_16x16x32_bf16 a[40:43], v[200:203], v[56:59], a[40:43]
    v_mfma_f32_16x16x32_bf16 a[44:47], v[204:207], v[56:59], a[44:47]
    buffer_load_dwordx4 v[132:135], v4, s[32:35], s22 offen offset:1024
    s_add_u32 s22, s22, 8192
    v_mfma_f32_16x16x32_bf16 a[48:51], v[200:203], v[60:63], a[48:51]
    v_mfma_f32_16x16x32_bf16 a[52:55], v[204:207], v[60:63], a[52:55]
    s_waitcnt vmcnt(12)
    s_barrier
    v_mfma_f32_16x16x32_bf16 a[56:59], v[200:203], v[64:67], a[56:59]
    v_mfma_f32_16x16x32_bf16 a[60:63], v[204:207], v[64:67], a[60:63]
    s_waitcnt lgkmcnt(0)
    v_mfma_f32_16x16x32_bf16 a[0:3], v[208:211], v[68:71], a[0:3]
    ds_read_b128 v[36:39], v103 offset:49152
    ds_read_b128 v[40:43], v103 offset:50176
    v_mfma_f32_16x16x32_bf16 a[4:7], v[212:215], v[68:71], a[4:7]
    ds_read_b128 v[44:47], v103 offset:51200
    ds_read_b128 v[48:51], v103 offset:52224
    v_mfma_f32_16x16x32_bf16 a[8:11], v[208:211], v[72:75], a[8:11]
    ds_read_b128 v[52:55], v103 offset:53248
    ds_read_b128 v[56:59], v103 offset:54272
    v_mfma_f32_16x16x32_bf16 a[12:15], v[212:215], v[72:75], a[12:15]
    ds_read_b128 v[60:63], v103 offset:55296
    ds_read_b128 v[64:67], v103 offset:56320
    v_mfma_f32_16x16x32_bf16 a[16:19], v[208:211], v[76:79], a[16:19]
    v_mfma_f32_16x16x32_bf16 a[20:23], v[212:215], v[76:79], a[20:23]
    s_add_u32 m0, s44, 16384
    s_nop 0
    buffer_load_dwordx4 v3, s[32:35], s21 offen offset:0 lds
    v_mfma_f32_16x16x32_bf16 a[24:27], v[208:211], v[80:83], a[24:27]
    v_mfma_f32_16x16x32_bf16 a[28:31], v[212:215], v[80:83], a[28:31]
    buffer_load_dwordx4 v3, s[32:35], s21 offen offset:1024 lds
    v_mfma_f32_16x16x32_bf16 a[32:35], v[208:211], v[84:87], a[32:35]
    v_mfma_f32_16x16x32_bf16 a[36:39], v[212:215], v[84:87], a[36:39]
    buffer_load_dwordx4 v3, s[32:35], s21 offen offset:2048 lds
    v_mfma_f32_16x16x32_bf16 a[40:43], v[208:211], v[88:91], a[40:43]
    v_mfma_f32_16x16x32_bf16 a[44:47], v[212:215], v[88:91], a[44:47]
    buffer_load_dwordx4 v3, s[32:35], s21 offen offset:3072 lds
    s_add_u32 s21, s21, 16384
    v_mfma_f32_16x16x32_bf16 a[48:51], v[208:211], v[92:95], a[48:51]
    v_mfma_f32_16x16x32_bf16 a[52:55], v[212:215], v[92:95], a[52:55]
    v_mfma_f32_16x16x32_bf16 a[56:59], v[208:211], v[96:99], a[56:59]
    v_mfma_f32_16x16x32_bf16 a[60:63], v[212:215], v[96:99], a[60:63]
    s_waitcnt lgkmcnt(0)
    v_mfma_f32_16x16x32_bf16 a[0:3], v[216:219], v[36:39], a[0:3]
    ds_read_b128 v[68:71], v103 offset:57344
    ds_read_b128 v[72:75], v103 offset:58368
    v_mfma_f32_16x16x32_bf16 a[4:7], v[220:223], v[36:39], a[4:7]
    ds_read_b128 v[76:79], v103 offset:59392
    ds_read_b128 v[80:83], v103 offset:60416
    v_mfma_f32_16x16x32_bf16 a[8:11], v[216:219], v[40:43], a[8:11]
    ds_read_b128 v[84:87], v103 offset:61440
    ds_read_b128 v[88:91], v103 offset:62464
    v_mfma_f32_16x16x32_bf16 a[12:15], v[220:223], v[40:43], a[12:15]
    ds_read_b128 v[92:95], v103 offset:63488
    ds_read_b128 v[96:99], v103 offset:64512
    v_mfma_f32_16x16x32_bf16 a[16:19], v[216:219], v[44:47], a[16:19]
    v_mfma_f32_16x16x32_bf16 a[20:23], v[220:223], v[44:47], a[20:23]
    buffer_load_dwordx4 v[136:139], v3, s[32:35], s22 offen offset:0
    v_mfma_f32_16x16x32_bf16 a[24:27], v[216:219], v[48:51], a[24:27]
    v_mfma_f32_16x16x32_bf16 a[28:31], v[220:223], v[48:51], a[28:31]
    buffer_load_dwordx4 v[140:143], v3, s[32:35], s22 offen offset:1024
    v_mfma_f32_16x16x32_bf16 a[32:35], v[216:219], v[52:55], a[32:35]
    v_mfma_f32_16x16x32_bf16 a[36:39], v[220:223], v[52:55], a[36:39]
    buffer_load_dwordx4 v[144:147], v4, s[32:35], s22 offen offset:0
    v_mfma_f32_16x16x32_bf16 a[40:43], v[216:219], v[56:59], a[40:43]
    v_mfma_f32_16x16x32_bf16 a[44:47], v[220:223], v[56:59], a[44:47]
    buffer_load_dwordx4 v[148:151], v4, s[32:35], s22 offen offset:1024
    s_add_u32 s22, s22, 8192
    v_mfma_f32_16x16x32_bf16 a[48:51], v[216:219], v[60:63], a[48:51]
    v_mfma_f32_16x16x32_bf16 a[52:55], v[220:223], v[60:63], a[52:55]
    s_waitcnt vmcnt(12)
    s_barrier
    v_mfma_f32_16x16x32_bf16 a[56:59], v[216:219], v[64:67], a[56:59]
    v_mfma_f32_16x16x32_bf16 a[60:63], v[220:223], v[64:67], a[60:63]
    s_waitcnt lgkmcnt(0)
    v_mfma_f32_16x16x32_bf16 a[0:3], v[224:227], v[68:71], a[0:3]
    ds_read_b128 v[36:39], v102 offset:0
    ds_read_b128 v[40:43], v102 offset:1024
    v_mfma_f32_16x16x32_bf16 a[4:7], v[228:231], v[68:71], a[4:7]
    ds_read_b128 v[44:47], v102 offset:2048
    ds_read_b128 v[48:51], v102 offset:3072
    v_mfma_f32_16x16x32_bf16 a[8:11], v[224:227], v[72:75], a[8:11]
    ds_read_b128 v[52:55], v102 offset:4096
    ds_read_b128 v[56:59], v102 offset:5120
    v_mfma_f32_16x16x32_bf16 a[12:15], v[228:231], v[72:75], a[12:15]
    ds_read_b128 v[60:63], v102 offset:6144
    ds_read_b128 v[64:67], v102 offset:7168
    v_mfma_f32_16x16x32_bf16 a[16:19], v[224:227], v[76:79], a[16:19]
    v_mfma_f32_16x16x32_bf16 a[20:23], v[228:231], v[76:79], a[20:23]
    s_add_u32 m0, s44, 32768
    s_nop 0
    buffer_load_dwordx4 v3, s[32:35], s21 offen offset:0 lds
    v_mfma_f32_16x16x32_bf16 a[24:27], v[224:227], v[80:83], a[24:27]
    v_mfma_f32_16x16x32_bf16 a[28:31], v[228:231], v[80:83], a[28:31]
    buffer_load_dwordx4 v3, s[32:35], s21 offen offset:1024 lds
    v_mfma_f32_16x16x32_bf16 a[32:35], v[224:227], v[84:87], a[32:35]
    v_mfma_f32_16x16x32_bf16 a[36:39], v[228:231], v[84:87], a[36:39]
    buffer_load_dwordx4 v3, s[32:35], s21 offen offset:2048 lds
    v_mfma_f32_16x16x32_bf16 a[40:43], v[224:227], v[88:91], a[40:43]
    v_mfma_f32_16x16x32_bf16 a[44:47], v[228:231], v[88:91], a[44:47]
    buffer_load_dwordx4 v3, s[32:35], s21 offen offset:3072 lds
    s_add_u32 s21, s21, 16384
    v_mfma_f32_16x16x32_bf16 a[48:51], v[224:227], v[92:95], a[48:51]
    v_mfma_f32_16x16x32_bf16 a[52:55], v[228:231], v[92:95], a[52:55]
    v_mfma_f32_16x16x32_bf16 a[56:59], v[224:227], v[96:99], a[56:59]
    v_mfma_f32_16x16x32_bf16 a[60:63], v[228:231], v[96:99], a[60:63]
    s_sub_u32 s39, s39, 1
    s_cmp_lg_u32 s39, 0
    s_cbranch_scc1 L_cl_g2
    s_waitcnt lgkmcnt(0)
    v_mfma_f32_16x16x32_bf16 a[0:3], v[104:107], v[36:39], a[0:3]
    ds_read_b128 v[68:71], v102 offset:8192
    ds_read_b128 v[72:75], v102 offset:9216
    v_mfma_f32_16x16x32_bf16 a[4:7], v[108:111], v[36:39], a[4:7]
    ds_read_b128 v[76:79], v102 offset:10240
    ds_read_b128 v[80:83], v102 offset:11264
    v_mfma_f32_16x16x32_bf16 a[8:11], v[104:107], v[40:43], a[8:11]
    ds_read_b128 v[84:87], v102 offset:12288
    ds_read_b128 v[88:91], v102 offset:13312
    v_mfma_f32_16x16x32_bf16 a[12:15], v[108:111], v[40:43], a[12:15]
    ds_read_b128 v[92:95], v102 offset:14336
    ds_read_b128 v[96:99], v102 offset:15360
    v_mfma_f32_16x16x32_bf16 a[16:19], v[104:107], v[44:47], a[16:19]
    v_mfma_f32_16x16x32_bf16 a[20:23], v[108:111], v[44:47], a[20:23]
    buffer_load_dwordx4 v[152:155], v3, s[32:35], s22 offen offset:0
    v_mfma_f32_16x16x32_bf16 a[24:27], v[104:107], v[48:51], a[24:27]
    v_mfma_f32_16x16x32_bf16 a[28:31], v[108:111], v[48:51], a[28:31]
    buffer_load_dwordx4 v[156:159], v3, s[32:35], s22 offen offset:1024
    v_mfma_f32_16x16x32_bf16 a[32:35], v[104:107], v[52:55], a[32:35]
    v_mfma_f32_16x16x32_bf16 a[36:39], v[108:111], v[52:55], a[36:39]
    buffer_load_dwordx4 v[160:163], v4, s[32:35], s22 offen offset:0
    v_mfma_f32_16x16x32_bf16 a[40:43], v[104:107], v[56:59], a[40:43]
    v_mfma_f32_16x16x32_bf16 a[44:47], v[108:111], v[56:59], a[44:47]
    buffer_load_dwordx4 v[164:167], v4, s[32:35], s22 offen offset:1024
    s_add_u32 s22, s22, 8192
    v_mfma_f32_16x16x32_bf16 a[48:51], v[104:107], v[60:63], a[48:51]
    v_mfma_f32_16x16x32_bf16 a[52:55], v[108:111], v[60:63], a[52:55]
    s_waitcnt vmcnt(12)
    s_barrier
    v_mfma_f32_16x16x32_bf16 a[56:59], v[104:107], v[64:67], a[56:59]
    v_mfma_f32_16x16x32_bf16 a[60:63], v[108:111], v[64:67], a[60:63]
    s_waitcnt lgkmcnt(0)
    v_mfma_f32_16x16x32_bf16 a[0:3], v[112:115], v[68:71], a[0:3]
    ds_read_b128 v[36:39], v102 offset:16384
    ds_read_b128 v[40:43], v102 offset:17408
    v_mfma_f32_16x16x32_bf16 a[4:7], v[116:119], v[68:71], a[4:7]
    ds_read_b128 v[44:47], v102 offset:18432
    ds_read_b128 v[48:51], v102 offset:19456
    v_mfma_f32_16x16x32_bf16 a[8:11], v[112:115], v[72:75], a[8:11]
    ds_read_b128 v[52:55], v102 offset:20480
    ds_read_b128 v[56:59], v102 offset:21504
    v_mfma_f32_16x16x32_bf16 a[12:15], v[116:119], v[72:75], a[12:15]
    ds_read_b128 v[60:63], v102 offset:22528
    ds_read_b128 v[64:67], v102 offset:23552
    v_mfma_f32_16x16x32_bf16 a[16:19], v[112:115], v[76:79], a[16:19]
    v_mfma_f32_16x16x32_bf16 a[20:23], v[116:119], v[76:79], a[20:23]
    s_add_u32 m0, s44, 49152
    s_nop 0
    buffer_load_dwordx4 v3, s[32:35], s21 offen offset:0 lds
    v_mfma_f32_16x16x32_bf16 a[24:27], v[112:115], v[80:83], a[24:27]
    v_mfma_f32_16x16x32_bf16 a[28:31], v[116:119], v[80:83], a[28:31]
    buffer_load_dwordx4 v3, s[32:35], s21 offen offset:1024 lds
    v_mfma_f32_16x16x32_bf16 a[32:35], v[112:115], v[84:87], a[32:35]
    v_mfma_f32_16x16x32_bf16 a[36:39], v[116:119], v[84:87], a[36:39]
    buffer_load_dwordx4 v3, s[32:35], s21 offen offset:2048 lds
    v_mfma_f32_16x16x32_bf16 a[40:43], v[112:115], v[88:91], a[40:43]
    v_mfma_f32_16x16x32_bf16 a[44:47], v[116:119], v[88:91], a[44:47]
    buffer_load_dwordx4 v3, s[32:35], s21 offen offset:3072 lds
    s_add_u32 s21, s21, 16384
    v_mfma_f32_16x16x32_bf16 a[48:51], v[112:115], v[92:95], a[48:51]
    v_mfma_f32_16x16x32_bf16 a[52:55], v[116:119], v[92:95], a[52:55]
    v_mfma_f32_16x16x32_bf16 a[56:59], v[112:115], v[96:99], a[56:59]
    v_mfma_f32_16x16x32_bf16 a[60:63], v[116:119], v[96:99], a[60:63]
    s_waitcnt lgkmcnt(0)
    v_mfma_f32_16x16x32_bf16 a[0:3], v[120:123], v[36:39], a[0:3]
    ds_read_b128 v[68:71], v102 offset:24576
    ds_read_b128 v[72:75], v102 offset:25600
    v_mfma_f32_16x16x32_bf16 a[4:7], v[124:127], v[36:39], a[4:7]
    ds_read_b128 v[76:79], v102 offset:26624
    ds_read_b128 v[80:83], v102 offset:27648
    v_mfma_f32_16x16x32_bf16 a[8:11], v[120:123], v[40:43], a[8:11]
    ds_read_b128 v[84:87], v102 offset:28672
    ds_read_b128 v[88:91], v102 offset:29696
    v_mfma_f32_16x16x32_bf16 a[12:15], v[124:127], v[40:43], a[12:15]
    ds_read_b128 v[92:95], v102 offset:30720
    ds_read_b128 v[96:99], v102 offset:31744
    v_mfma_f32_16x16x32_bf16 a[16:19], v[120:123], v[44:47], a[16:19]
    v_mfma_f32_16x16x32_bf16 a[20:23], v[124:127], v[44:47], a[20:23]
    v_mfma_f32_16x16x32_bf16 a[24:27], v[120:123], v[48:51], a[24:27]
    v_mfma_f32_16x16x32_bf16 a[28:31], v[124:127], v[48:51], a[28:31]
    v_mfma_f32_16x16x32_bf16 a[32:35], v[120:123], v[52:55], a[32:35]
    v_mfma_f32_16x16x32_bf16 a[36:39], v[124:127], v[52:55], a[36:39]
    v_mfma_f32_16x16x32_bf16 a[40:43], v[120:123], v[56:59], a[40:43]
    v_mfma_f32_16x16x32_bf16 a[44:47], v[124:127], v[56:59], a[44:47]
    v_mfma_f32_16x16x32_bf16 a[48:51], v[120:123], v[60:63], a[48:51]
    v_mfma_f32_16x16x32_bf16 a[52:55], v[124:127], v[60:63], a[52:55]
    s_waitcnt vmcnt(8)
    s_barrier
    v_mfma_f32_16x16x32_bf16 a[56:59], v[120:123], v[64:67], a[56:59]
    v_mfma_f32_16x16x32_bf16 a[60:63], v[124:127], v[64:67], a[60:63]
    s_waitcnt lgkmcnt(0)
    v_mfma_f32_16x16x32_bf16 a[0:3], v[128:131], v[68:71], a[0:3]
    ds_read_b128 v[36:39], v102 offset:32768
    ds_read_b128 v[40:43], v102 offset:33792
    v_mfma_f32_16x16x32_bf16 a[4:7], v[132:135], v[68:71], a[4:7]
    ds_read_b128 v[44:47], v102 offset:34816
    ds_read_b128 v[48:51], v102 offset:35840
    v_mfma_f32_16x16x32_bf16 a[8:11], v[128:131], v[72:75], a[8:11]
    ds_read_b128 v[52:55], v102 offset:36864
    ds_read_b128 v[56:59], v102 offset:37888
    v_mfma_f32_16x16x32_bf16 a[12:15], v[132:135], v[72:75], a[12:15]
    ds_read_b128 v[60:63], v102 offset:38912
    ds_read_b128 v[64:67], v102 offset:39936
    v_mfma_f32_16x16x32_bf16 a[16:19], v[128:131], v[76:79], a[16:19]
    v_mfma_f32_16x16x32_bf16 a[20:23], v[132:135], v[76:79], a[20:23]
    s_add_u32 s49, s38, 0
    buffer_load_dwordx4 v[16:19], v32, s[32:35], s49 offen sc1
    buffer_load_dwordx4 v[8:11], v6, s[28:31], s37 offen
    v_mfma_f32_16x16x32_bf16 a[24:27], v[128:131], v[80:83], a[24:27]
    v_mfma_f32_16x16x32_bf16 a[28:31], v[132:135], v[80:83], a[28:31]
    s_add_u32 s49, s38, 32768
    buffer_load_dwordx4 v[20:23], v32, s[32:35], s49 offen sc1
    v_mfma_f32_16x16x32_bf16 a[32:35], v[128:131], v[84:87], a[32:35]
    v_mfma_f32_16x16x32_bf16 a[36:39], v[132:135], v[84:87], a[36:39]
    s_add_u32 s49, s38, 65536
    buffer_load_dwordx4 v[24:27], v32, s[32:35], s49 offen sc1
    v_mfma_f32_16x16x32_bf16 a[40:43], v[128:131], v[88:91], a[40:43]
    v_mfma_f32_16x16x32_bf16 a[44:47], v[132:135], v[88:91], a[44:47]
    s_add_u32 s49, s38, 98304
    buffer_load_dwordx4 v[28:31], v32, s[32:35], s49 offen sc1
    v_mfma_f32_16x16x32_bf16 a[48:51], v[128:131], v[92:95], a[48:51]
    v_mfma_f32_16x16x32_bf16 a[52:55], v[132:135], v[92:95], a[52:55]
    v_mfma_f32_16x16x32_bf16 a[56:59], v[128:131], v[96:99], a[56:59]
    v_mfma_f32_16x16x32_bf16 a[60:63], v[132:135], v[96:99], a[60:63]
    s_waitcnt lgkmcnt(0)
    v_mfma_f32_16x16x32_bf16 a[0:3], v[136:139], v[36:39], a[0:3]
    ds_read_b128 v[68:71], v102 offset:40960
    ds_read_b128 v[72:75], v102 offset:41984
    v_mfma_f32_16x16x32_bf16 a[4:7], v[140:143], v[36:39], a[4:7]
    ds_read_b128 v[76:79], v102 offset:43008
    ds_read_b128 v[80:83], v102 offset:44032
    v_mfma_f32_16x16x32_bf16 a[8:11], v[136:139], v[40:43], a[8:11]
    ds_read_b128 v[84:87], v102 offset:45056
    ds_read_b128 v[88:91], v102 offset:46080
    v_mfma_f32_16x16x32_bf16 a[12:15], v[140:143], v[40:43], a[12:15]
    ds_read_b128 v[92:95], v102 offset:47104
    ds_read_b128 v[96:99], v102 offset:48128
    v_mfma_f32_16x16x32_bf16 a[16:19], v[136:139], v[44:47], a[16:19]
    v_mfma_f32_16x16x32_bf16 a[20:23], v[140:143], v[44:47], a[20:23]
    v_mfma_f32_16x16x32_bf16 a[24:27], v[136:139], v[48:51], a[24:27]
    v_mfma_f32_16x16x32_bf16 a[28:31], v[140:143], v[48:51], a[28:31]
    v_mfma_f32_16x16x32_bf16 a[32:35], v[136:139], v[52:55], a[32:35]
    v_mfma_f32_16x16x32_bf16 a[36:39], v[140:143], v[52:55], a[36:39]
    v_mfma_f32_16x16x32_bf16 a[40:43], v[136:139], v[56:59], a[40:43]
    v_mfma_f32_16x16x32_bf16 a[44:47], v[140:143], v[56:59], a[44:47]
    v_mfma_f32_16x16x32_bf16 a[48:51], v[136:139], v[60:63], a[48:51]
    v_mfma_f32_16x16x32_bf16 a[52:55], v[140:143], v[60:63], a[52:55]
    s_waitcnt vmcnt(5)
    s_barrier
    v_mfma_f32_16x16x32_bf16 a[56:59], v[136:139], v[64:67], a[56:59]
    v_mfma_f32_16x16x32_bf16 a[60:63], v[140:143], v[64:67], a[60:63]
    s_waitcnt lgkmcnt(0)
    v_mfma_f32_16x16x32_bf16 a[0:3], v[144:147], v[68:71], a[0:3]
    ds_read_b128 v[36:39], v102 offset:49152
    ds_read_b128 v[40:43], v102 offset:50176
    v_mfma_f32_16x16x32_bf16 a[4:7], v[148:151], v[68:71], a[4:7]
    ds_read_b128 v[44:47], v102 offset:51200
    ds_read_b128 v[48:51], v102 offset:52224
    v_mfma_f32_16x16x32_bf16 a[8:11], v[144:147], v[72:75], a[8:11]
    ds_read_b128 v[52:55], v102 offset:53248
    ds_read_b128 v[56:59], v102 offset:54272
    v_mfma_f32_16x16x32_bf16 a[12:15], v[148:151], v[72:75], a[12:15]
    ds_read_b128 v[60:63], v102 offset:55296
    ds_read_b128 v[64:67], v102 offset:56320
    v_mfma_f32_16x16x32_bf16 a[16:19], v[144:147], v[76:79], a[16:19]
    v_mfma_f32_16x16x32_bf16 a[20:23], v[148:151], v[76:79], a[20:23]
    v_mfma_f32_16x16x32_bf16 a[24:27], v[144:147], v[80:83], a[24:27]
    v_mfma_f32_16x16x32_bf16 a[28:31], v[148:151], v[80:83], a[28:31]
    v_mfma_f32_16x16x32_bf16 a[32:35], v[144:147], v[84:87], a[32:35]
    v_mfma_f32_16x16x32_bf16 a[36:39], v[148:151], v[84:87], a[36:39]
    v_mfma_f32_16x16x32_bf16 a[40:43], v[144:147], v[88:91], a[40:43]
    v_mfma_f32_16x16x32_bf16 a[44:47], v[148:151], v[88:91], a[44:47]
    v_mfma_f32_16x16x32_bf16 a[48:51], v[144:147], v[92:95], a[48:51]
    v_mfma_f32_16x16x32_bf16 a[52:55], v[148:151], v[92:95], a[52:55]
    v_mfma_f32_16x16x32_bf16 a[56:59], v[144:147], v[96:99], a[56:59]
    v_mfma_f32_16x16x32_bf16 a[60:63], v[148:151], v[96:99], a[60:63]
    s_waitcnt lgkmcnt(0)
    s_cmp_lg_u32 s60, 0
    s_cbranch_scc1 L_l1_g2
    s_sub_u32 s49, s46, 1
    v_mfma_f32_16x16x32_bf16 a[0:3], v[152:155], v[36:39], a[0:3]
    ds_read_b128 v[68:71], v102 offset:57344
    ds_read_b128 v[72:75], v102 offset:58368
    v_mfma_f32_16x16x32_bf16 a[4:7], v[156:159], v[36:39], a[4:7]
    ds_read_b128 v[76:79], v102 offset:59392
    ds_read_b128 v[80:83], v102 offset:60416
    v_mfma_f32_16x16x32_bf16 a[8:11], v[152:155], v[40:43], a[8:11]
    ds_read_b128 v[84:87], v102 offset:61440
    ds_read_b128 v[88:91], v102 offset:62464
    v_mfma_f32_16x16x32_bf16 a[12:15], v[156:159], v[40:43], a[12:15]
    ds_read_b128 v[92:95], v102 offset:63488
    ds_read_b128 v[96:99], v102 offset:64512
    v_mfma_f32_16x16x32_bf16 a[16:19], v[152:155], v[44:47], a[16:19]
    s_waitcnt vmcnt(0)
    v_and_b32 v8, s49, v8
    v_lshlrev_b32 v16, 16, v8
    v_mfma_f32_16x16x32_bf16 a[20:23], v[156:159], v[44:47], a[20:23]
    v_and_b32 v20, 0xffff0000, v8
    v_and_b32 v9, s49, v9
    v_lshlrev_b32 v17, 16, v9
    v_mfma_f32_16x16x32_bf16 a[24:27], v[152:155], v[48:51], a[24:27]
    v_and_b32 v21, 0xffff0000, v9
    v_and_b32 v10, s49, v10
    v_lshlrev_b32 v18, 16, v10
    v_mfma_f32_16x16x32_bf16 a[28:31], v[156:159], v[48:51], a[28:31]
    v_and_b32 v22, 0xffff0000, v10
    v_and_b32 v11, s49, v11
    v_lshlrev_b32 v19, 16, v11
    v_mfma_f32_16x16x32_bf16 a[32:35], v[152:155], v[52:55], a[32:35]
    v_and_b32 v23, 0xffff0000, v11
    v_mfma_f32_16x16x32_bf16 a[36:39], v[156:159], v[52:55], a[36:39]
    v_mfma_f32_16x16x32_bf16 a[40:43], v[152:155], v[56:59], a[40:43]
    v_mfma_f32_16x16x32_bf16 a[44:47], v[156:159], v[56:59], a[44:47]
    s_waitcnt lgkmcnt(0)
    v_mfma_f32_16x16x32_bf16 a[0:3], v[160:163], v[68:71], a[0:3]
    v_mfma_f32_16x16x32_bf16 a[4:7], v[164:167], v[68:71], a[4:7]
    v_mfma_f32_16x16x32_bf16 a[8:11], v[160:163], v[72:75], a[8:11]
    v_mfma_f32_16x16x32_bf16 a[12:15], v[164:167], v[72:75], a[12:15]
    v_mfma_f32_16x16x32_bf16 a[16:19], v[160:163], v[76:79], a[16:19]
    v_mfma_f32_16x16x32_bf16 a[20:23], v[164:167], v[76:79], a[20:23]
    v_accvgpr_read_b32 v176, a0
    v_accvgpr_read_b32 v177, a1
    v_accvgpr_read_b32 v178, a2
    v_mfma_f32_16x16x32_bf16 a[24:27], v[160:163], v[80:83], a[24:27]
    v_accvgpr_read_b32 v179, a3
    v_accvgpr_read_b32 v180, a4
    v_accvgpr_read_b32 v181, a5
    v_mfma_f32_16x16x32_bf16 a[28:31], v[164:167], v[80:83], a[28:31]
    v_accvgpr_read_b32 v182, a6
    v_accvgpr_read_b32 v183, a7
    v_pk_add_f32 v[176:177], v[176:177], v[16:17]
    v_mfma_f32_16x16x32_bf16 a[48:51], v[152:155], v[60:63], a[48:51]
    v_pk_add_f32 v[178:179], v[178:179], v[18:19]
    v_pk_add_f32 v[180:181], v[180:181], v[20:21]
    v_pk_add_f32 v[182:183], v[182:183], v[22:23]
    v_mfma_f32_16x16x32_bf16 a[52:55], v[156:159], v[60:63], a[52:55]
    v_cvt_pk_bf16_f32 v176, v176, v180
    v_cvt_pk_bf16_f32 v177, v177, v181
    v_cvt_pk_bf16_f32 v178, v178, v182
    v_mfma_f32_16x16x32_bf16 a[56:59], v[152:155], v[64:67], a[56:59]
    v_cvt_pk_bf16_f32 v179, v179, v183
    buffer_store_dwordx4 v[176:179], v5, s[32:35], s38 offen sc1
    s_add_u32 s38, s38, 32768
    v_accvgpr_read_b32 v184, a8
    v_mfma_f32_16x16x32_bf16 a[60:63], v[156:159], v[64:67], a[60:63]
    v_accvgpr_read_b32 v185, a9
    v_accvgpr_read_b32 v186, a10
    v_accvgpr_read_b32 v187, a11
    v_mfma_f32_16x16x32_bf16 a[32:35], v[160:163], v[84:87], a[32:35]
    v_accvgpr_read_b32 v188, a12
    v_accvgpr_read_b32 v189, a13
    v_accvgpr_read_b32 v190, a14
    v_mfma_f32_16x16x32_bf16 a[36:39], v[164:167], v[84:87], a[36:39]
    v_accvgpr_read_b32 v191, a15
    v_pk_add_f32 v[184:185], v[184:185], v[16:17]
    v_pk_add_f32 v[186:187], v[186:187], v[18:19]
    v_mfma_f32_16x16x32_bf16 a[40:43], v[160:163], v[88:91], a[40:43]
    v_pk_add_f32 v[188:189], v[188:189], v[20:21]
    v_pk_add_f32 v[190:191], v[190:191], v[22:23]
    v_cvt_pk_bf16_f32 v184, v184, v188
    v_mfma_f32_16x16x32_bf16 a[44:47], v[164:167], v[88:91], a[44:47]
    v_cvt_pk_bf16_f32 v185, v185, v189
    v_cvt_pk_bf16_f32 v186, v186, v190
    v_cvt_pk_bf16_f32 v187, v187, v191
    v_mfma_f32_16x16x32_bf16 a[48:51], v[160:163], v[92:95], a[48:51]
    buffer_store_dwordx4 v[184:187], v5, s[32:35], s38 offen sc1
    s_add_u32 s38, s38, 32768
    v_accvgpr_read_b32 v192, a16
    v_accvgpr_read_b32 v193, a17
    v_mfma_f32_16x16x32_bf16 a[52:55], v[164:167], v[92:95], a[52:55]
    v_accvgpr_read_b32 v194, a18
    v_accvgpr_read_b32 v195, a19
    v_accvgpr_read_b32 v196, a20
    v_mfma_f32_16x16x32_bf16 a[56:59], v[160:163], v[96:99], a[56:59]
    v_accvgpr_read_b32 v197, a21
    v_accvgpr_read_b32 v198, a22
    v_accvgpr_read_b32 v199, a23
    v_mfma_f32_16x16x32_bf16 a[60:63], v[164:167], v[96:99], a[60:63]
    v_pk_add_f32 v[192:193], v[192:193], v[16:17]
    v_pk_add_f32 v[194:195], v[194:195], v[18:19]
    v_pk_add_f32 v[196:197], v[196:197], v[20:21]
    s_nop 7
    v_pk_add_f32 v[198:199], v[198:199], v[22:23]
    v_cvt_pk_bf16_f32 v192, v192, v196
    v_cvt_pk_bf16_f32 v193, v193, v197
    v_cvt_pk_bf16_f32 v194, v194, v198
    v_cvt_pk_bf16_f32 v195, v195, v199
    buffer_store_dwordx4 v[192:195], v5, s[32:35], s38 offen sc1
    s_add_u32 s38, s38, 32768
    v_accvgpr_read_b32 v200, a24
    v_accvgpr_read_b32 v201, a25
    v_accvgpr_read_b32 v202, a26
    v_accvgpr_read_b32 v203, a27
    v_accvgpr_read_b32 v204, a28
    v_accvgpr_read_b32 v205, a29
    v_accvgpr_read_b32 v206, a30
    v_accvgpr_read_b32 v207, a31
    v_pk_add_f32 v[200:201], v[200:201], v[16:17]
    v_pk_add_f32 v[202:203], v[202:203], v[18:19]
    v_pk_add_f32 v[204:205], v[204:205], v[20:21]
    v_pk_add_f32 v[206:207], v[206:207], v[22:23]
    v_cvt_pk_bf16_f32 v200, v200, v204
    v_cvt_pk_bf16_f32 v201, v201, v205
    v_cvt_pk_bf16_f32 v202, v202, v206
    v_cvt_pk_bf16_f32 v203, v203, v207
    buffer_store_dwordx4 v[200:203], v5, s[32:35], s38 offen sc1
    s_add_u32 s38, s38, 32768
    v_accvgpr_read_b32 v208, a32
    v_accvgpr_read_b32 v209, a33
    v_accvgpr_read_b32 v210, a34
    v_accvgpr_read_b32 v211, a35
    v_accvgpr_read_b32 v212, a36
    v_accvgpr_read_b32 v213, a37
    v_accvgpr_read_b32 v214, a38
    v_accvgpr_read_b32 v215, a39
    v_pk_add_f32 v[208:209], v[208:209], v[16:17]
    v_pk_add_f32 v[210:211], v[210:211], v[18:19]
    v_pk_add_f32 v[212:213], v[212:213], v[20:21]
    v_pk_add_f32 v[214:215], v[214:215], v[22:23]
    v_cvt_pk_bf16_f32 v208, v208, v212
    v_cvt_pk_bf16_f32 v209, v209, v213
    v_cvt_pk_bf16_f32 v210, v210, v214
    v_cvt_pk_bf16_f32 v211, v211, v215
    buffer_store_dwordx4 v[208:211], v5, s[32:35], s38 offen sc1
    s_add_u32 s38, s38, 32768
    v_accvgpr_read_b32 v216, a40
    v_accvgpr_read_b32 v217, a41
    v_accvgpr_read_b32 v218, a42
    v_accvgpr_read_b32 v219, a43
    v_accvgpr_read_b32 v220, a44
    v_accvgpr_read_b32 v221, a45
    v_accvgpr_read_b32 v222, a46
    v_accvgpr_read_b32 v223, a47
    v_pk_add_f32 v[216:217], v[216:217], v[16:17]
    v_pk_add_f32 v[218:219], v[218:219], v[18:19]
    v_pk_add_f32 v[220:221], v[220:221], v[20:21]
    v_pk_add_f32 v[222:223], v[222:223], v[22:23]
    v_cvt_pk_bf16_f32 v216, v216, v220
    v_cvt_pk_bf16_f32 v217, v217, v221
    v_cvt_pk_bf16_f32 v218, v218, v222
    v_cvt_pk_bf16_f32 v219, v219, v223
    buffer_store_dwordx4 v[216:219], v5, s[32:35], s38 offen sc1
    s_add_u32 s38, s38, 32768
    v_accvgpr_read_b32 v224, a48
    v_accvgpr_read_b32 v225, a49
    v_accvgpr_read_b32 v226, a50
    v_accvgpr_read_b32 v227, a51
    v_accvgpr_read_b32 v228, a52
    v_accvgpr_read_b32 v229, a53
    v_accvgpr_read_b32 v230, a54
    v_accvgpr_read_b32 v231, a55
    v_pk_add_f32 v[224:225], v[224:225], v[16:17]
    v_pk_add_f32 v[226:227], v[226:227], v[18:19]
    v_pk_add_f32 v[228:229], v[228:229], v[20:21]
    v_pk_add_f32 v[230:231], v[230:231], v[22:23]
    v_cvt_pk_bf16_f32 v224, v224, v228
    v_cvt_pk_bf16_f32 v225, v225, v229
    v_cvt_pk_bf16_f32 v226, v226, v230
    v_cvt_pk_bf16_f32 v227, v227, v231
    buffer_store_dwordx4 v[224:227], v5, s[32:35], s38 offen sc1
    s_add_u32 s38, s38, 32768
    v_accvgpr_read_b32 v232, a56
    v_accvgpr_read_b32 v233, a57
    v_accvgpr_read_b32 v234, a58
    v_accvgpr_read_b32 v235, a59
    v_accvgpr_read_b32 v236, a60
    v_accvgpr_read_b32 v237, a61
    v_accvgpr_read_b32 v238, a62
    v_accvgpr_read_b32 v239, a63
    v_pk_add_f32 v[232:233], v[232:233], v[16:17]
    v_pk_add_f32 v[234:235], v[234:235], v[18:19]
    v_pk_add_f32 v[236:237], v[236:237], v[20:21]
    v_pk_add_f32 v[238:239], v[238:239], v[22:23]
    v_cvt_pk_bf16_f32 v232, v232, v236
    v_cvt_pk_bf16_f32 v233, v233, v237
    v_cvt_pk_bf16_f32 v234, v234, v238
    v_cvt_pk_bf16_f32 v235, v235, v239
    buffer_store_dwordx4 v[232:235], v5, s[32:35], s38 offen sc1
    s_add_u32 s38, s38, 32768
    s_branch L_g2e
L_l1_g2:
    s_cmp_eq_u32 s46, 1
    s_cbranch_scc1 L_k1_g2
    v_mfma_f32_16x16x32_bf16 a[32:35], v[152:155], v[52:55], a[32:35]
    ds_read_b128 v[84:87], v102 offset:61440
    ds_read_b128 v[88:91], v102 offset:62464
    v_mfma_f32_16x16x32_bf16 a[36:39], v[156:159], v[52:55], a[36:39]
    ds_read_b128 v[92:95], v102 offset:63488
    ds_read_b128 v[96:99], v102 offset:64512
    v_mfma_f32_16x16x32_bf16 a[40:43], v[152:155], v[56:59], a[40:43]
    ds_read_b128 v[68:71], v102 offset:57344
    ds_read_b128 v[72:75], v102 offset:58368
    v_mfma_f32_16x16x32_bf16 a[44:47], v[156:159], v[56:59], a[44:47]
    ds_read_b128 v[76:79], v102 offset:59392
    ds_read_b128 v[80:83], v102 offset:60416
    v_mfma_f32_16x16x32_bf16 a[48:51], v[152:155], v[60:63], a[48:51]
    v_mov_b32 v107, s64
    v_mov_b32 v111, s64
    v_mov_b32 v115, s64
    v_mfma_f32_16x16x32_bf16 a[52:55], v[156:159], v[60:63], a[52:55]
    v_mov_b32 v119, s64
    v_mov_b32 v123, s64
    v_mov_b32 v127, s64
    v_mfma_f32_16x16x32_bf16 a[56:59], v[152:155], v[64:67], a[56:59]
    v_mfma_f32_16x16x32_bf16 a[60:63], v[156:159], v[64:67], a[60:63]
    v_mfma_f32_16x16x32_bf16 a[0:3], v[152:155], v[36:39], a[0:3]
    v_mfma_f32_16x16x32_bf16 a[4:7], v[156:159], v[36:39], a[4:7]
    v_mfma_f32_16x16x32_bf16 a[8:11], v[152:155], v[40:43], a[8:11]
    v_mfma_f32_16x16x32_bf16 a[12:15], v[156:159], v[40:43], a[12:15]
    s_waitcnt lgkmcnt(0)
    v_mfma_f32_16x16x32_bf16 a[32:35], v[160:163], v[84:87], a[32:35]
    v_mfma_f32_16x16x32_bf16 a[36:39], v[164:167], v[84:87], a[36:39]
    v_mfma_f32_16x16x32_bf16 a[40:43], v[160:163], v[88:91], a[40:43]
    v_mfma_f32_16x16x32_bf16 a[44:47], v[164:167], v[88:91], a[44:47]
    v_mfma_f32_16x16x32_bf16 a[48:51], v[160:163], v[92:95], a[48:51]
    v_mfma_f32_16x16x32_bf16 a[52:55], v[164:167], v[92:95], a[52:55]
    v_accvgpr_read_b32 v128, a32
    v_accvgpr_read_b32 v129, a33
    v_accvgpr_read_b32 v130, a34
    v_mfma_f32_16x16x32_bf16 a[56:59], v[160:163], v[96:99], a[56:59]
    v_accvgpr_read_b32 v131, a35
    v_accvgpr_read_b32 v132, a36
    v_accvgpr_read_b32 v133, a37
    v_mfma_f32_16x16x32_bf16 a[60:63], v[164:167], v[96:99], a[60:63]
    v_cvt_pk_bf16_f32 v104, v128, v129
    v_cvt_pk_bf16_f32 v105, v130, v131
    v_cvt_pk_bf16_f32 v106, v132, v133
    v_mfma_f32_16x16x32_bf16 a[16:19], v[152:155], v[44:47], a[16:19]
    buffer_store_dwordx4 v[104:107], v3, s[32:35], s50 offen offset:0 sc1
    v_accvgpr_read_b32 v128, a38
    v_accvgpr_read_b32 v129, a39
    v_mfma_f32_16x16x32_bf16 a[20:23], v[156:159], v[44:47], a[20:23]
    v_accvgpr_read_b32 v130, a40
    v_accvgpr_read_b32 v131, a41
    v_accvgpr_read_b32 v132, a42
    v_mfma_f32_16x16x32_bf16 a[24:27], v[152:155], v[48:51], a[24:27]
    v_accvgpr_read_b32 v133, a43
    v_cvt_pk_bf16_f32 v108, v128, v129
    v_cvt_pk_bf16_f32 v109, v130, v131
    v_mfma_f32_16x16x32_bf16 a[28:31], v[156:159], v[48:51], a[28:31]
    v_cvt_pk_bf16_f32 v110, v132, v133
    buffer_store_dwordx4 v[108:111], v3, s[32:35], s50 offen offset:1024 sc1
    v_accvgpr_read_b32 v128, a44
    v_mfma_f32_16x16x32_bf16 a[0:3], v[160:163], v[68:71], a[0:3]
    v_accvgpr_read_b32 v129, a45
    v_accvgpr_read_b32 v130, a46
    v_accvgpr_read_b32 v131, a47
    v_mfma_f32_16x16x32_bf16 a[4:7], v[164:167], v[68:71], a[4:7]
    v_accvgpr_read_b32 v132, a48
    v_accvgpr_read_b32 v133, a49
    v_cvt_pk_bf16_f32 v112, v128, v129
    v_mfma_f32_16x16x32_bf16 a[8:11], v[160:163], v[72:75], a[8:11]
    v_cvt_pk_bf16_f32 v113, v130, v131
    v_cvt_pk_bf16_f32 v114, v132, v133
    buffer_store_dwordx4 v[112:115], v3, s[32:35], s50 offen offset:2048 sc1
    v_mfma_f32_16x16x32_bf16 a[12:15], v[164:167], v[72:75], a[12:15]
    v_accvgpr_read_b32 v128, a50
    v_accvgpr_read_b32 v129, a51
    v_accvgpr_read_b32 v130, a52
    v_mfma_f32_16x16x32_bf16 a[16:19], v[160:163], v[76:79], a[16:19]
    v_accvgpr_read_b32 v131, a53
    v_accvgpr_read_b32 v132, a54
    v_accvgpr_read_b32 v133, a55
    v_mfma_f32_16x16x32_bf16 a[20:23], v[164:167], v[76:79], a[20:23]
    v_cvt_pk_bf16_f32 v116, v128, v129
    v_cvt_pk_bf16_f32 v117, v130, v131
    v_cvt_pk_bf16_f32 v118, v132, v133
    v_mfma_f32_16x16x32_bf16 a[24:27], v[160:163], v[80:83], a[24:27]
    buffer_store_dwordx4 v[116:119], v3, s[32:35], s50 offen offset:3072 sc1
    v_accvgpr_read_b32 v128, a56
    v_accvgpr_read_b32 v129, a57
    v_mfma_f32_16x16x32_bf16 a[28:31], v[164:167], v[80:83], a[28:31]
    v_accvgpr_read_b32 v130, a58
    v_accvgpr_read_b32 v131, a59
    v_accvgpr_read_b32 v132, a60
    s_nop 7
    v_accvgpr_read_b32 v133, a61
    v_cvt_pk_bf16_f32 v120, v128, v129
    v_cvt_pk_bf16_f32 v121, v130, v131
    v_cvt_pk_bf16_f32 v122, v132, v133
    buffer_store_dwordx4 v[120:123], v4, s[32:35], s50 offen offset:0 sc1
    v_accvgpr_read_b32 v128, a62
    v_accvgpr_read_b32 v129, a63
    v_cvt_pk_bf16_f32 v124, v128, v129
    buffer_store_dwordx4 v[124:127], v4, s[32:35], s50 offen offset:1024 sc1
    v_accvgpr_read_b32 v36, a0
    v_accvgpr_read_b32 v37, a1
    v_accvgpr_read_b32 v38, a2
    v_accvgpr_read_b32 v39, a3
    v_accvgpr_read_b32 v40, a4
    v_accvgpr_read_b32 v41, a5
    v_accvgpr_read_b32 v42, a6
    v_accvgpr_read_b32 v43, a7
    v_accvgpr_read_b32 v44, a8
    v_accvgpr_read_b32 v45, a9
    v_accvgpr_read_b32 v46, a10
    v_accvgpr_read_b32 v47, a11
    v_accvgpr_read_b32 v48, a12
    v_accvgpr_read_b32 v49, a13
    v_accvgpr_read_b32 v50, a14
    v_accvgpr_read_b32 v51, a15
    v_accvgpr_read_b32 v52, a16
    v_accvgpr_read_b32 v53, a17
    v_accvgpr_read_b32 v54, a18
    v_accvgpr_read_b32 v55, a19
    v_accvgpr_read_b32 v56, a20
    v_accvgpr_read_b32 v57, a21
    v_accvgpr_read_b32 v58, a22
    v_accvgpr_read_b32 v59, a23
    v_accvgpr_read_b32 v60, a24
    v_accvgpr_read_b32 v61, a25
    v_accvgpr_read_b32 v62, a26
    v_accvgpr_read_b32 v63, a27
    v_accvgpr_read_b32 v64, a28
    v_accvgpr_read_b32 v65, a29
    v_accvgpr_read_b32 v66, a30
    v_accvgpr_read_b32 v67, a31
    s_branch L_kd_g2
L_k1_g2:
    v_mfma_f32_16x16x32_bf16 a[0:3], v[152:155], v[36:39], a[0:3]
    ds_read_b128 v[68:71], v102 offset:57344
    ds_read_b128 v[72:75], v102 offset:58368
    v_mfma_f32_16x16x32_bf16 a[4:7], v[156:159], v[36:39], a[4:7]
    ds_read_b128 v[76:79], v102 offset:59392
    ds_read_b128 v[80:83], v102 offset:60416
    v_mfma_f32_16x16x32_bf16 a[8:11], v[152:155], v[40:43], a[8:11]
    ds_read_b128 v[84:87], v102 offset:61440
    ds_read_b128 v[88:91], v102 offset:62464
    v_mfma_f32_16x16x32_bf16 a[12:15], v[156:159], v[40:43], a[12:15]
    ds_read_b128 v[92:95], v102 offset:63488
    ds_read_b128 v[96:99], v102 offset:64512
    v_mfma_f32_16x16x32_bf16 a[16:19], v[152:155], v[44:47], a[16:19]
    v_mov_b32 v107, s64
    v_mov_b32 v111, s64
    v_mov_b32 v115, s64
    v_mfma_f32_16x16x32_bf16 a[20:23], v[156:159], v[44:47], a[20:23]
    v_mov_b32 v119, s64
    v_mov_b32 v123, s64
    v_mov_b32 v127, s64
    v_mfma_f32_16x16x32_bf16 a[24:27], v[152:155], v[48:51], a[24:27]
    v_mfma_f32_16x16x32_bf16 a[28:31], v[156:159], v[48:51], a[28:31]
    v_mfma_f32_16x16x32_bf16 a[32:35], v[152:155], v[52:55], a[32:35]
    v_mfma_f32_16x16x32_bf16 a[36:39], v[156:159], v[52:55], a[36:39]
    v_mfma_f32_16x16x32_bf16 a[40:43], v[152:155], v[56:59], a[40:43]
    v_mfma_f32_16x16x32_bf16 a[44:47], v[156:159], v[56:59], a[44:47]
    s_waitcnt lgkmcnt(0)
    v_mfma_f32_16x16x32_bf16 a[0:3], v[160:163], v[68:71], a[0:3]
    v_mfma_f32_16x16x32_bf16 a[4:7], v[164:167], v[68:71], a[4:7]
    v_mfma_f32_16x16x32_bf16 a[8:11], v[160:163], v[72:75], a[8:11]
    v_mfma_f32_16x16x32_bf16 a[12:15], v[164:167], v[72:75], a[12:15]
    v_mfma_f32_16x16x32_bf16 a[16:19], v[160:163], v[76:79], a[16:19]
    v_mfma_f32_16x16x32_bf16 a[20:23], v[164:167], v[76:79], a[20:23]
    v_accvgpr_read_b32 v128, a0
    v_accvgpr_read_b32 v129, a1
    v_accvgpr_read_b32 v130, a2
    v_mfma_f32_16x16x32_bf16 a[24:27], v[160:163], v[80:83], a[24:27]
    v_accvgpr_read_b32 v131, a3
    v_accvgpr_read_b32 v132, a4
    v_accvgpr_read_b32 v133, a5
    v_mfma_f32_16x16x32_bf16 a[28:31], v[164:167], v[80:83], a[28:31]
    v_cvt_pk_bf16_f32 v104, v128, v129
    v_cvt_pk_bf16_f32 v105, v130, v131
    v_cvt_pk_bf16_f32 v106, v132, v133
    v_mfma_f32_16x16x32_bf16 a[48:51], v[152:155], v[60:63], a[48:51]
    buffer_store_dwordx4 v[104:107], v3, s[32:35], s50 offen offset:0 sc1
    v_accvgpr_read_b32 v128, a6
    v_accvgpr_read_b32 v129, a7
    v_mfma_f32_16x16x32_bf16 a[52:55], v[156:159], v[60:63], a[52:55]
    v_accvgpr_read_b32 v130, a8
    v_accvgpr_read_b32 v131, a9
    v_accvgpr_read_b32 v132, a10
    v_mfma_f32_16x16x32_bf16 a[56:59], v[152:155], v[64:67], a[56:59]
    v_accvgpr_read_b32 v133, a11
    v_cvt_pk_bf16_f32 v108, v128, v129
    v_cvt_pk_bf16_f32 v109, v130, v131
    v_mfma_f32_16x16x32_bf16 a[60:63], v[156:159], v[64:67], a[60:63]
    v_cvt_pk_bf16_f32 v110, v132, v133
    buffer_store_dwordx4 v[108:111], v3, s[32:35], s50 offen offset:1024 sc1
    v_accvgpr_read_b32 v128, a12
    v_mfma_f32_16x16x32_bf16 a[32:35], v[160:163], v[84:87], a[32:35]
    v_accvgpr_read_b32 v129, a13
    v_accvgpr_read_b32 v130, a14
    v_accvgpr_read_b32 v131, a15
    v_mfma_f32_16x16x32_bf16 a[36:39], v[164:167], v[84:87], a[36:39]
    v_accvgpr_read_b32 v132, a16
    v_accvgpr_read_b32 v133, a17
    v_cvt_pk_bf16_f32 v112, v128, v129
    v_mfma_f32_16x16x32_bf16 a[40:43], v[160:163], v[88:91], a[40:43]
    v_cvt_pk_bf16_f32 v113, v130, v131
    v_cvt_pk_bf16_f32 v114, v132, v133
    buffer_store_dwordx4 v[112:115], v3, s[32:35], s50 offen offset:2048 sc1
    v_mfma_f32_16x16x32_bf16 a[44:47], v[164:167], v[88:91], a[44:47]
    v_accvgpr_read_b32 v128, a18
    v_accvgpr_read_b32 v129, a19
    v_accvgpr_read_b32 v130, a20
    v_mfma_f32_16x16x32_bf16 a[48:51], v[160:163], v[92:95], a[48:51]
    v_accvgpr_read_b32 v131, a21
    v_accvgpr_read_b32 v132, a22
    v_accvgpr_read_b32 v133, a23
    v_mfma_f32_16x16x32_bf16 a[52:55], v[164:167], v[92:95], a[52:55]
    v_cvt_pk_bf16_f32 v116, v128, v129
    v_cvt_pk_bf16_f32 v117, v130, v131
    v_cvt_pk_bf16_f32 v118, v132, v133
    v_mfma_f32_16x16x32_bf16 a[56:59], v[160:163], v[96:99], a[56:59]
    buffer_store_dwordx4 v[116:119], v3, s[32:35], s50 offen offset:3072 sc1
    v_accvgpr_read_b32 v128, a24
    v_accvgpr_read_b32 v129, a25
    v_mfma_f32_16x16x32_bf16 a[60:63], v[164:167], v[96:99], a[60:63]
    v_accvgpr_read_b32 v130, a26
    v_accvgpr_read_b32 v131, a27
    v_accvgpr_read_b32 v132, a28
    s_nop 7
    v_accvgpr_read_b32 v133, a29
    v_cvt_pk_bf16_f32 v120, v128, v129
    v_cvt_pk_bf16_f32 v121, v130, v131
    v_cvt_pk_bf16_f32 v122, v132, v133
    buffer_store_dwordx4 v[120:123], v4, s[32:35], s50 offen offset:0 sc1
    v_accvgpr_read_b32 v128, a30
    v_accvgpr_read_b32 v129, a31
    v_cvt_pk_bf16_f32 v124, v128, v129
    buffer_store_dwordx4 v[124:127], v4, s[32:35], s50 offen offset:1024 sc1
    v_accvgpr_read_b32 v36, a32
    v_accvgpr_read_b32 v37, a33
    v_accvgpr_read_b32 v38, a34
    v_accvgpr_read_b32 v39, a35
    v_accvgpr_read_b32 v40, a36
    v_accvgpr_read_b32 v41, a37
    v_accvgpr_read_b32 v42, a38
    v_accvgpr_read_b32 v43, a39
    v_accvgpr_read_b32 v44, a40
    v_accvgpr_read_b32 v45, a41
    v_accvgpr_read_b32 v46, a42
    v_accvgpr_read_b32 v47, a43
    v_accvgpr_read_b32 v48, a44
    v_accvgpr_read_b32 v49, a45
    v_accvgpr_read_b32 v50, a46
    v_accvgpr_read_b32 v51, a47
    v_accvgpr_read_b32 v52, a48
    v_accvgpr_read_b32 v53, a49
    v_accvgpr_read_b32 v54, a50
    v_accvgpr_read_b32 v55, a51
    v_accvgpr_read_b32 v56, a52
    v_accvgpr_read_b32 v57, a53
    v_accvgpr_read_b32 v58, a54
    v_accvgpr_read_b32 v59, a55
    v_accvgpr_read_b32 v60, a56
    v_accvgpr_read_b32 v61, a57
    v_accvgpr_read_b32 v62, a58
    v_accvgpr_read_b32 v63, a59
    v_accvgpr_read_b32 v64, a60
    v_accvgpr_read_b32 v65, a61
    v_accvgpr_read_b32 v66, a62
    v_accvgpr_read_b32 v67, a63
L_kd_g2:
    s_waitcnt vmcnt(6)
    s_mov_b32 s39, 0x40000
    v_lshlrev_b32 v33, 16, v8
    v_and_b32 v34, 0xffff0000, v8
    v_add_f32 v36, v36, v33
    v_add_f32 v40, v40, v34
    v_add_f32 v44, v44, v33
    v_add_f32 v48, v48, v34
    v_add_f32 v52, v52, v33
    v_add_f32 v56, v56, v34
    v_add_f32 v60, v60, v33
    v_add_f32 v64, v64, v34
    v_lshlrev_b32 v33, 16, v9
    v_and_b32 v34, 0xffff0000, v9
    v_add_f32 v37, v37, v33
    v_add_f32 v41, v41, v34
    v_add_f32 v45, v45, v33
    v_add_f32 v49, v49, v34
    v_add_f32 v53, v53, v33
    v_add_f32 v57, v57, v34
    v_add_f32 v61, v61, v33
    v_add_f32 v65, v65, v34
    v_lshlrev_b32 v33, 16, v10
    v_and_b32 v34, 0xffff0000, v10
    v_add_f32 v38, v38, v33
    v_add_f32 v42, v42, v34
    v_add_f32 v46, v46, v33
    v_add_f32 v50, v50, v34
    v_add_f32 v54, v54, v33
    v_add_f32 v58, v58, v34
    v_add_f32 v62, v62, v33
    v_add_f32 v66, v66, v34
    v_lshlrev_b32 v33, 16, v11
    v_and_b32 v34, 0xffff0000, v11
    v_add_f32 v39, v39, v33
    v_add_f32 v43, v43, v34
    v_add_f32 v47, v47, v33
    v_add_f32 v51, v51, v34
    v_add_f32 v55, v55, v33
    v_add_f32 v59, v59, v34
    v_add_f32 v63, v63, v33
    v_add_f32 v67, v67, v34
    s_waitcnt vmcnt(0)
L_px_g2:
    buffer_load_dwordx4 v[152:155], v3, s[32:35], s51 offen offset:0 sc1
    buffer_load_dwordx4 v[156:159], v3, s[32:35], s51 offen offset:1024 sc1
    buffer_load_dwordx4 v[160:163], v3, s[32:35], s51 offen offset:2048 sc1
    buffer_load_dwordx4 v[164:167], v3, s[32:35], s51 offen offset:3072 sc1
    buffer_load_dwordx4 v[168:171], v4, s[32:35], s51 offen offset:0 sc1
    buffer_load_dwordx4 v[172:175], v4, s[32:35], s51 offen offset:1024 sc1
    s_waitcnt vmcnt(0)
    v_mov_b32 v33, 0
    v_xor_b32 v34, s64, v155
    v_xor_b32 v35, s64, v159
    v_or3_b32 v33, v33, v34, v35
    v_xor_b32 v34, s64, v163
    v_xor_b32 v35, s64, v167
    v_or3_b32 v33, v33, v34, v35
    v_xor_b32 v34, s64, v171
    v_xor_b32 v35, s64, v175
    v_or3_b32 v33, v33, v34, v35
    v_cmp_ne_u32 vcc, 0, v33
    s_cmp_eq_u64 vcc, 0
    s_cbranch_scc1 L_pd_g2
    s_sub_u32 s39, s39, 1
    s_cmp_lg_u32 s39, 0
    s_cbranch_scc1 L_px_g2
L_pd_g2:
    v_lshlrev_b32 v32, 16, v152
    v_and_b32 v33, 0xffff0000, v152
    v_pk_add_f32 v[36:37], v[36:37], v[32:33]
    v_lshlrev_b32 v32, 16, v153
    v_and_b32 v33, 0xffff0000, v153
    v_pk_add_f32 v[38:39], v[38:39], v[32:33]
    v_lshlrev_b32 v32, 16, v154
    v_and_b32 v33, 0xffff0000, v154
    v_pk_add_f32 v[40:41], v[40:41], v[32:33]
    v_lshlrev_b32 v32, 16, v156
    v_and_b32 v33, 0xffff0000, v156
    v_pk_add_f32 v[42:43], v[42:43], v[32:33]
    v_cvt_pk_bf16_f32 v35, v36, v40
    v_lshlrev_b32 v33, 16, v16
    v_and_b32 v34, 0xffff0000, v16
    v_lshlrev_b32 v36, 16, v35
    v_and_b32 v40, 0xffff0000, v35
    v_add_f32 v33, v33, v36
    v_add_f32 v34, v34, v40
    v_cvt_pk_bf16_f32 v16, v33, v34
    v_cvt_pk_bf16_f32 v35, v37, v41
    v_lshlrev_b32 v33, 16, v17
    v_and_b32 v34, 0xffff0000, v17
    v_lshlrev_b32 v37, 16, v35
    v_and_b32 v41, 0xffff0000, v35
    v_add_f32 v33, v33, v37
    v_add_f32 v34, v34, v41
    v_cvt_pk_bf16_f32 v17, v33, v34
    v_cvt_pk_bf16_f32 v35, v38, v42
    v_lshlrev_b32 v33, 16, v18
    v_and_b32 v34, 0xffff0000, v18
    v_lshlrev_b32 v38, 16, v35
    v_and_b32 v42, 0xffff0000, v35
    v_add_f32 v33, v33, v38
    v_add_f32 v34, v34, v42
    v_cvt_pk_bf16_f32 v18, v33, v34
    v_cvt_pk_bf16_f32 v35, v39, v43
    v_lshlrev_b32 v33, 16, v19
    v_and_b32 v34, 0xffff0000, v19
    v_lshlrev_b32 v39, 16, v35
    v_and_b32 v43, 0xffff0000, v35
    v_add_f32 v33, v33, v39
    v_add_f32 v34, v34, v43
    v_cvt_pk_bf16_f32 v19, v33, v34
    buffer_store_dwordx4 v[16:19], v5, s[24:27], s36 offen sc1
    s_add_u32 s36, s36, 32768
    v_lshlrev_b32 v32, 16, v157
    v_and_b32 v33, 0xffff0000, v157
    v_pk_add_f32 v[44:45], v[44:45], v[32:33]
    v_lshlrev_b32 v32, 16, v158
    v_and_b32 v33, 0xffff0000, v158
    v_pk_add_f32 v[46:47], v[46:47], v[32:33]
    v_lshlrev_b32 v32, 16, v160
    v_and_b32 v33, 0xffff0000, v160
    v_pk_add_f32 v[48:49], v[48:49], v[32:33]
    v_lshlrev_b32 v32, 16, v161
    v_and_b32 v33, 0xffff0000, v161
    v_pk_add_f32 v[50:51], v[50:51], v[32:33]
    v_cvt_pk_bf16_f32 v35, v44, v48
    v_lshlrev_b32 v33, 16, v20
    v_and_b32 v34, 0xffff0000, v20
    v_lshlrev_b32 v44, 16, v35
    v_and_b32 v48, 0xffff0000, v35
    v_add_f32 v33, v33, v44
    v_add_f32 v34, v34, v48
    v_cvt_pk_bf16_f32 v20, v33, v34
    v_cvt_pk_bf16_f32 v35, v45, v49
    v_lshlrev_b32 v33, 16, v21
    v_and_b32 v34, 0xffff0000, v21
    v_lshlrev_b32 v45, 16, v35
    v_and_b32 v49, 0xffff0000, v35
    v_add_f32 v33, v33, v45
    v_add_f32 v34, v34, v49
    v_cvt_pk_bf16_f32 v21, v33, v34
    v_cvt_pk_bf16_f32 v35, v46, v50
    v_lshlrev_b32 v33, 16, v22
    v_and_b32 v34, 0xffff0000, v22
    v_lshlrev_b32 v46, 16, v35
    v_and_b32 v50, 0xffff0000, v35
    v_add_f32 v33, v33, v46
    v_add_f32 v34, v34, v50
    v_cvt_pk_bf16_f32 v22, v33, v34
    v_cvt_pk_bf16_f32 v35, v47, v51
    v_lshlrev_b32 v33, 16, v23
    v_and_b32 v34, 0xffff0000, v23
    v_lshlrev_b32 v47, 16, v35
    v_and_b32 v51, 0xffff0000, v35
    v_add_f32 v33, v33, v47
    v_add_f32 v34, v34, v51
    v_cvt_pk_bf16_f32 v23, v33, v34
    buffer_store_dwordx4 v[20:23], v5, s[24:27], s36 offen sc1
    s_add_u32 s36, s36, 32768
    v_lshlrev_b32 v32, 16, v162
    v_and_b32 v33, 0xffff0000, v162
    v_pk_add_f32 v[52:53], v[52:53], v[32:33]
    v_lshlrev_b32 v32, 16, v164
    v_and_b32 v33, 0xffff0000, v164
    v_pk_add_f32 v[54:55], v[54:55], v[32:33]
    v_lshlrev_b32 v32, 16, v165
    v_and_b32 v33, 0xffff0000, v165
    v_pk_add_f32 v[56:57], v[56:57], v[32:33]
    v_lshlrev_b32 v32, 16, v166
    v_and_b32 v33, 0xffff0000, v166
    v_pk_add_f32 v[58:59], v[58:59], v[32:33]
    v_cvt_pk_bf16_f32 v35, v52, v56
    v_lshlrev_b32 v33, 16, v24
    v_and_b32 v34, 0xffff0000, v24
    v_lshlrev_b32 v52, 16, v35
    v_and_b32 v56, 0xffff0000, v35
    v_add_f32 v33, v33, v52
    v_add_f32 v34, v34, v56
    v_cvt_pk_bf16_f32 v24, v33, v34
    v_cvt_pk_bf16_f32 v35, v53, v57
    v_lshlrev_b32 v33, 16, v25
    v_and_b32 v34, 0xffff0000, v25
    v_lshlrev_b32 v53, 16, v35
    v_and_b32 v57, 0xffff0000, v35
    v_add_f32 v33, v33, v53
    v_add_f32 v34, v34, v57
    v_cvt_pk_bf16_f32 v25, v33, v34
    v_cvt_pk_bf16_f32 v35, v54, v58
    v_lshlrev_b32 v33, 16, v26
    v_and_b32 v34, 0xffff0000, v26
    v_lshlrev_b32 v54, 16, v35
    v_and_b32 v58, 0xffff0000, v35
    v_add_f32 v33, v33, v54
    v_add_f32 v34, v34, v58
    v_cvt_pk_bf16_f32 v26, v33, v34
    v_cvt_pk_bf16_f32 v35, v55, v59
    v_lshlrev_b32 v33, 16, v27
    v_and_b32 v34, 0xffff0000, v27
    v_lshlrev_b32 v55, 16, v35
    v_and_b32 v59, 0xffff0000, v35
    v_add_f32 v33, v33, v55
    v_add_f32 v34, v34, v59
    v_cvt_pk_bf16_f32 v27, v33, v34
    buffer_store_dwordx4 v[24:27], v5, s[24:27], s36 offen sc1
    s_add_u32 s36, s36, 32768
    v_lshlrev_b32 v32, 16, v168
    v_and_b32 v33, 0xffff0000, v168
    v_pk_add_f32 v[60:61], v[60:61], v[32:33]
    v_lshlrev_b32 v32, 16, v169
    v_and_b32 v33, 0xffff0000, v169
    v_pk_add_f32 v[62:63], v[62:63], v[32:33]
    v_lshlrev_b32 v32, 16, v170
    v_and_b32 v33, 0xffff0000, v170
    v_pk_add_f32 v[64:65], v[64:65], v[32:33]
    v_lshlrev_b32 v32, 16, v172
    v_and_b32 v33, 0xffff0000, v172
    v_pk_add_f32 v[66:67], v[66:67], v[32:33]
    v_cvt_pk_bf16_f32 v35, v60, v64
    v_lshlrev_b32 v33, 16, v28
    v_and_b32 v34, 0xffff0000, v28
    v_lshlrev_b32 v60, 16, v35
    v_and_b32 v64, 0xffff0000, v35
    v_add_f32 v33, v33, v60
    v_add_f32 v34, v34, v64
    v_cvt_pk_bf16_f32 v28, v33, v34
    v_cvt_pk_bf16_f32 v35, v61, v65
    v_lshlrev_b32 v33, 16, v29
    v_and_b32 v34, 0xffff0000, v29
    v_lshlrev_b32 v61, 16, v35
    v_and_b32 v65, 0xffff0000, v35
    v_add_f32 v33, v33, v61
    v_add_f32 v34, v34, v65
    v_cvt_pk_bf16_f32 v29, v33, v34
    v_cvt_pk_bf16_f32 v35, v62, v66
    v_lshlrev_b32 v33, 16, v30
    v_and_b32 v34, 0xffff0000, v30
    v_lshlrev_b32 v62, 16, v35
    v_and_b32 v66, 0xffff0000, v35
    v_add_f32 v33, v33, v62
    v_add_f32 v34, v34, v66
    v_cvt_pk_bf16_f32 v30, v33, v34
    v_cvt_pk_bf16_f32 v35, v63, v67
    v_lshlrev_b32 v33, 16, v31
    v_and_b32 v34, 0xffff0000, v31
    v_lshlrev_b32 v63, 16, v35
    v_and_b32 v67, 0xffff0000, v35
    v_add_f32 v33, v33, v63
    v_add_f32 v34, v34, v67
    v_cvt_pk_bf16_f32 v31, v33, v34
    buffer_store_dwordx4 v[28:31], v5, s[24:27], s36 offen sc1
    s_add_u32 s36, s36, 32768
    s_branch L_fin
L_g2e:
    s_mov_b32 s60, 1
    s_mov_b32 s61, 25165824
    s_mov_b32 s63, 58720256
    s_lshl_b32 s40, s20, 12
    s_mul_i32 s41, s20, 7168
    s_lshl_b32 s42, s16, 18
    s_add_u32 s42, s42, s40
    s_add_u32 s42, s42, s61
    s_mul_i32 s43, s17, 458752
    s_add_u32 s43, s43, s41
    s_add_u32 s43, s43, 4194304
    s_add_u32 s41, s41, 16384
    s_mov_b32 s44, 0
    s_mov_b32 s44, 0
    s_and_b32 s21, s20, 1
    s_lshr_b32 s22, s20, 1
    v_lshrrev_b32 v4, 4, v2
    v_lshlrev_b32 v4, 4, v4
    s_mul_i32 s23, s17, 896
    s_mul_i32 s24, s22, 448
    s_add_u32 s23, s23, s24
    s_add_u32 s23, s23, 79691776
    buffer_load_dwordx4 v[104:107], v4, s[32:35], s23 offen offset:0
    buffer_load_dwordx4 v[108:111], v4, s[32:35], s23 offen offset:64
    buffer_load_dwordx4 v[112:115], v4, s[32:35], s23 offen offset:128
    buffer_load_dwordx4 v[116:119], v4, s[32:35], s23 offen offset:192
    buffer_load_dwordx4 v[120:123], v4, s[32:35], s23 offen offset:256
    buffer_load_dwordx4 v[124:127], v4, s[32:35], s23 offen offset:320
    buffer_load_dwordx4 v[128:131], v4, s[32:35], s23 offen offset:384
    v_and_b32 v27, 7, v2
    v_lshrrev_b32 v28, 3, v2
    s_lshl_b32 s52, s20, 9
    v_lshlrev_b32 v14, 11, v27
    v_lshl_add_u32 v14, v28, 4, v14
    v_add_u32 v14, s52, v14
    s_lshl_b32 s52, s20, 12
    v_lshlrev_b32 v15, 7, v28
    v_lshl_add_u32 v15, v27, 3, v15
    v_add_u32 v15, s52, v15
    s_lshl_b32 s52, s20, 2
    v_lshlrev_b32 v24, 5, v27
    v_add_u32 v24, 135168, v24
    v_lshrrev_b32 v25, 5, v2
    v_lshl_add_u32 v25, v25, 4, v24
    v_add_u32 v25, s52, v25
    s_lshl_b32 s52, s20, 16
    v_lshrrev_b32 v26, 2, v28
    v_lshlrev_b32 v26, 13, v26
    v_and_b32 v28, 3, v28
    v_lshl_add_u32 v26, v28, 8, v26
    v_lshl_add_u32 v26, v27, 4, v26
    v_add_u32 v26, s52, v26
    s_lshl_b32 s53, s16, 18
    s_lshr_b32 s52, s17, 1
    s_lshl_b32 s52, s52, 10
    s_add_u32 s53, s53, s52
    s_and_b32 s52, s17, 1
    s_lshl_b32 s52, s52, 7
    s_add_u32 s53, s53, s52
    s_add_u32 s53, s53, s61
    s_lshl_b32 s52, s16, 4
    s_add_u32 s52, s52, s17
    s_lshl_b32 s52, s52, 14
    v_accvgpr_read_b32 v80, a128
    v_accvgpr_read_b32 v64, a240
    v_accvgpr_read_b32 v81, a129
    v_accvgpr_read_b32 v65, a241
    v_accvgpr_read_b32 v82, a130
    v_accvgpr_read_b32 v66, a242
    v_accvgpr_read_b32 v83, a131
    v_accvgpr_read_b32 v67, a243
    v_accvgpr_read_b32 v84, a132
    v_accvgpr_read_b32 v68, a244
    v_accvgpr_read_b32 v85, a133
    v_accvgpr_read_b32 v69, a245
    v_accvgpr_read_b32 v86, a134
    v_accvgpr_read_b32 v70, a246
    v_accvgpr_read_b32 v87, a135
    v_accvgpr_read_b32 v71, a247
    v_accvgpr_read_b32 v88, a136
    v_accvgpr_read_b32 v72, a248
    v_accvgpr_read_b32 v89, a137
    v_accvgpr_read_b32 v73, a249
    v_accvgpr_read_b32 v90, a138
    v_accvgpr_read_b32 v74, a250
    v_accvgpr_read_b32 v91, a139
    v_accvgpr_read_b32 v75, a251
    v_accvgpr_read_b32 v92, a140
    v_accvgpr_read_b32 v76, a252
    v_accvgpr_read_b32 v93, a141
    v_accvgpr_read_b32 v77, a253
    v_accvgpr_read_b32 v94, a142
    v_accvgpr_read_b32 v78, a254
    v_accvgpr_read_b32 v95, a143
    v_accvgpr_read_b32 v79, a255
    v_lshlrev_b32 v32, 16, v64
    v_and_b32 v33, 0xffff0000, v64
    v_lshlrev_b32 v34, 16, v65
    v_and_b32 v35, 0xffff0000, v65
    v_lshlrev_b32 v36, 16, v66
    v_and_b32 v37, 0xffff0000, v66
    v_lshlrev_b32 v38, 16, v67
    v_and_b32 v39, 0xffff0000, v67
    v_lshlrev_b32 v40, 16, v68
    v_and_b32 v41, 0xffff0000, v68
    v_lshlrev_b32 v42, 16, v69
    v_and_b32 v43, 0xffff0000, v69
    v_lshlrev_b32 v44, 16, v70
    v_and_b32 v45, 0xffff0000, v70
    v_lshlrev_b32 v46, 16, v71
    v_and_b32 v47, 0xffff0000, v71
    v_lshlrev_b32 v48, 16, v72
    v_and_b32 v49, 0xffff0000, v72
    v_lshlrev_b32 v50, 16, v73
    v_and_b32 v51, 0xffff0000, v73
    v_lshlrev_b32 v52, 16, v74
    v_and_b32 v53, 0xffff0000, v74
    v_lshlrev_b32 v54, 16, v75
    v_and_b32 v55, 0xffff0000, v75
    v_lshlrev_b32 v56, 16, v76
    v_and_b32 v57, 0xffff0000, v76
    v_lshlrev_b32 v58, 16, v77
    v_and_b32 v59, 0xffff0000, v77
    v_lshlrev_b32 v60, 16, v78
    v_and_b32 v61, 0xffff0000, v78
    v_lshlrev_b32 v62, 16, v79
    v_and_b32 v63, 0xffff0000, v79
    v_lshlrev_b32 v208, 16, v80
    v_and_b32 v209, 0xffff0000, v80
    v_lshlrev_b32 v210, 16, v81
    v_and_b32 v211, 0xffff0000, v81
    v_lshlrev_b32 v212, 16, v82
    v_and_b32 v213, 0xffff0000, v82
    v_lshlrev_b32 v214, 16, v83
    v_and_b32 v215, 0xffff0000, v83
    v_lshlrev_b32 v216, 16, v84
    v_and_b32 v217, 0xffff0000, v84
    v_lshlrev_b32 v218, 16, v85
    v_and_b32 v219, 0xffff0000, v85
    v_lshlrev_b32 v220, 16, v86
    v_and_b32 v221, 0xffff0000, v86
    v_lshlrev_b32 v222, 16, v87
    v_and_b32 v223, 0xffff0000, v87
    v_lshlrev_b32 v224, 16, v88
    v_and_b32 v225, 0xffff0000, v88
    v_lshlrev_b32 v226, 16, v89
    v_and_b32 v227, 0xffff0000, v89
    v_lshlrev_b32 v228, 16, v90
    v_and_b32 v229, 0xffff0000, v90
    v_lshlrev_b32 v230, 16, v91
    v_and_b32 v231, 0xffff0000, v91
    v_lshlrev_b32 v232, 16, v92
    v_and_b32 v233, 0xffff0000, v92
    v_lshlrev_b32 v234, 16, v93
    v_and_b32 v235, 0xffff0000, v93
    v_lshlrev_b32 v236, 16, v94
    v_and_b32 v237, 0xffff0000, v94
    v_lshlrev_b32 v238, 16, v95
    v_and_b32 v239, 0xffff0000, v95
    s_add_u32 s66, s78, s65
    s_add_u32 s66, s66, 65536
    v_mov_b32 v12, s64
    v_lshlrev_b32 v13, 10, v2
    s_waitcnt vmcnt(0)
    s_barrier
    s_cmp_lg_u32 s20, 0
    s_cbranch_scc1 L_sg4807
    s_mov_b64 exec, 1
    buffer_store_dword v12, v13, s[32:35], s66 offen sc1
    s_mov_b64 exec, -1
L_sg4807:
    s_or_b32 s54, s2, s20
    s_cmp_lg_u32 s54, 0
    s_cbranch_scc1 L_nn
    v_mov_b32 v12, s64
    v_mov_b32 v13, 0
    s_mov_b32 s54, 81264640
    s_mov_b64 exec, 1
    buffer_store_dword v12, v13, s[32:35], s54 offen sc1
    s_mov_b64 exec, -1
L_nn:
    s_cmp_lg_u32 s20, 0
    s_cbranch_scc1 L_wt4823d
    s_add_u32 s66, s79, s65
    s_add_u32 s66, s66, 65536
    v_and_b32 v13, 48, v3
    s_mov_b32 s67, 0x40000
L_wt4823:
    buffer_load_dwordx4 v[8:11], v13, s[32:35], s66 offen sc1
    s_waitcnt vmcnt(0)
    v_xor_b32 v8, s64, v8
    v_xor_b32 v9, s64, v9
    v_xor_b32 v10, s64, v10
    v_xor_b32 v11, s64, v11
    v_or3_b32 v8, v8, v9, v10
    v_or_b32 v12, v8, v11
    v_cmp_ne_u32 vcc, 0, v12
    s_cmp_eq_u64 vcc, 0
    s_cbranch_scc1 L_wt4823d
    s_sub_u32 s67, s67, 1
    s_cmp_lg_u32 s67, 0
    s_cbranch_scc1 L_wt4823
L_wt4823d:
    s_barrier
    s_add_u32 s54, s52, 75497472
    s_add_u32 s55, s52, 0
    s_add_u32 s65, s65, 49152
    buffer_load_dwordx4 v[140:143], v14, s[32:35], s54 offen offset:0 sc1
    buffer_load_dwordx4 v[156:159], v14, s[32:35], s55 offen offset:0 sc1
    buffer_load_dwordx4 v[144:147], v14, s[32:35], s54 offen offset:128 sc1
    buffer_load_dwordx4 v[160:163], v14, s[32:35], s55 offen offset:128 sc1
    buffer_load_dwordx4 v[148:151], v14, s[32:35], s54 offen offset:256 sc1
    buffer_load_dwordx4 v[164:167], v14, s[32:35], s55 offen offset:256 sc1
    buffer_load_dwordx4 v[152:155], v14, s[32:35], s54 offen offset:384 sc1
    buffer_load_dwordx4 v[168:171], v14, s[32:35], s55 offen offset:384 sc1
    v_accvgpr_write_b32 a0, 0
    v_accvgpr_write_b32 a1, 0
    v_accvgpr_write_b32 a2, 0
    v_accvgpr_write_b32 a3, 0
    v_accvgpr_write_b32 a4, 0
    v_accvgpr_write_b32 a5, 0
    v_accvgpr_write_b32 a6, 0
    v_accvgpr_write_b32 a7, 0
    v_accvgpr_write_b32 a8, 0
    v_accvgpr_write_b32 a9, 0
    v_accvgpr_write_b32 a10, 0
    v_accvgpr_write_b32 a11, 0
    v_accvgpr_write_b32 a12, 0
    v_accvgpr_write_b32 a13, 0
    v_accvgpr_write_b32 a14, 0
    v_accvgpr_write_b32 a15, 0
    v_accvgpr_write_b32 a16, 0
    v_accvgpr_write_b32 a17, 0
    v_accvgpr_write_b32 a18, 0
    v_accvgpr_write_b32 a19, 0
    v_accvgpr_write_b32 a20, 0
    v_accvgpr_write_b32 a21, 0
    v_accvgpr_write_b32 a22, 0
    v_accvgpr_write_b32 a23, 0
    v_accvgpr_write_b32 a24, 0
    v_accvgpr_write_b32 a25, 0
    v_accvgpr_write_b32 a26, 0
    v_accvgpr_write_b32 a27, 0
    v_accvgpr_write_b32 a28, 0
    v_accvgpr_write_b32 a29, 0
    v_accvgpr_write_b32 a30, 0
    v_accvgpr_write_b32 a31, 0
    v_accvgpr_write_b32 a32, 0
    v_accvgpr_write_b32 a33, 0
    v_accvgpr_write_b32 a34, 0
    v_accvgpr_write_b32 a35, 0
    v_accvgpr_write_b32 a36, 0
    v_accvgpr_write_b32 a37, 0
    v_accvgpr_write_b32 a38, 0
    v_accvgpr_write_b32 a39, 0
    v_accvgpr_write_b32 a40, 0
    v_accvgpr_write_b32 a41, 0
    v_accvgpr_write_b32 a42, 0
    v_accvgpr_write_b32 a43, 0
    v_accvgpr_write_b32 a44, 0
    v_accvgpr_write_b32 a45, 0
    v_accvgpr_write_b32 a46, 0
    v_accvgpr_write_b32 a47, 0
    v_accvgpr_write_b32 a48, 0
    v_accvgpr_write_b32 a49, 0
    v_accvgpr_write_b32 a50, 0
    v_accvgpr_write_b32 a51, 0
    v_accvgpr_write_b32 a52, 0
    v_accvgpr_write_b32 a53, 0
    v_accvgpr_write_b32 a54, 0
    v_accvgpr_write_b32 a55, 0
    v_accvgpr_write_b32 a56, 0
    v_accvgpr_write_b32 a57, 0
    v_accvgpr_write_b32 a58, 0
    v_accvgpr_write_b32 a59, 0
    v_accvgpr_write_b32 a60, 0
    v_accvgpr_write_b32 a61, 0
    v_accvgpr_write_b32 a62, 0
    v_accvgpr_write_b32 a63, 0
    s_waitcnt vmcnt(6)
    v_lshlrev_b32 v176, 16, v140
    v_and_b32 v177, 0xffff0000, v140
    v_lshlrev_b32 v178, 16, v156
    v_and_b32 v179, 0xffff0000, v156
    v_lshlrev_b32 v180, 16, v141
    v_and_b32 v181, 0xffff0000, v141
    v_lshlrev_b32 v182, 16, v157
    v_and_b32 v183, 0xffff0000, v157
    v_lshlrev_b32 v184, 16, v142
    v_and_b32 v185, 0xffff0000, v142
    v_lshlrev_b32 v186, 16, v158
    v_and_b32 v187, 0xffff0000, v158
    v_lshlrev_b32 v188, 16, v143
    v_and_b32 v189, 0xffff0000, v143
    v_lshlrev_b32 v190, 16, v159
    v_and_b32 v191, 0xffff0000, v159
    v_pk_add_f32 v[32:33], v[176:177], v[32:33]
    v_pk_add_f32 v[34:35], v[180:181], v[34:35]
    v_pk_add_f32 v[36:37], v[184:185], v[36:37]
    v_pk_add_f32 v[38:39], v[188:189], v[38:39]
    v_pk_add_f32 v[32:33], v[178:179], v[32:33]
    v_pk_add_f32 v[34:35], v[182:183], v[34:35]
    v_pk_add_f32 v[36:37], v[186:187], v[36:37]
    v_pk_add_f32 v[38:39], v[190:191], v[38:39]
    s_waitcnt vmcnt(4)
    v_lshlrev_b32 v192, 16, v144
    v_and_b32 v193, 0xffff0000, v144
    v_lshlrev_b32 v194, 16, v160
    v_and_b32 v195, 0xffff0000, v160
    v_lshlrev_b32 v196, 16, v145
    v_and_b32 v197, 0xffff0000, v145
    v_lshlrev_b32 v198, 16, v161
    v_and_b32 v199, 0xffff0000, v161
    v_lshlrev_b32 v200, 16, v146
    v_and_b32 v201, 0xffff0000, v146
    v_lshlrev_b32 v202, 16, v162
    v_and_b32 v203, 0xffff0000, v162
    v_lshlrev_b32 v204, 16, v147
    v_and_b32 v205, 0xffff0000, v147
    v_lshlrev_b32 v206, 16, v163
    v_and_b32 v207, 0xffff0000, v163
    v_pk_add_f32 v[40:41], v[192:193], v[40:41]
    v_pk_add_f32 v[42:43], v[196:197], v[42:43]
    v_pk_add_f32 v[44:45], v[200:201], v[44:45]
    v_pk_add_f32 v[46:47], v[204:205], v[46:47]
    v_pk_add_f32 v[40:41], v[194:195], v[40:41]
    v_pk_add_f32 v[42:43], v[198:199], v[42:43]
    v_pk_add_f32 v[44:45], v[202:203], v[44:45]
    v_pk_add_f32 v[46:47], v[206:207], v[46:47]
    s_waitcnt vmcnt(2)
    v_lshlrev_b32 v176, 16, v148
    v_and_b32 v177, 0xffff0000, v148
    v_lshlrev_b32 v178, 16, v164
    v_and_b32 v179, 0xffff0000, v164
    v_lshlrev_b32 v180, 16, v149
    v_and_b32 v181, 0xffff0000, v149
    v_lshlrev_b32 v182, 16, v165
    v_and_b32 v183, 0xffff0000, v165
    v_lshlrev_b32 v184, 16, v150
    v_and_b32 v185, 0xffff0000, v150
    v_lshlrev_b32 v186, 16, v166
    v_and_b32 v187, 0xffff0000, v166
    v_lshlrev_b32 v188, 16, v151
    v_and_b32 v189, 0xffff0000, v151
    v_lshlrev_b32 v190, 16, v167
    v_and_b32 v191, 0xffff0000, v167
    v_pk_add_f32 v[48:49], v[176:177], v[48:49]
    v_pk_add_f32 v[50:51], v[180:181], v[50:51]
    v_pk_add_f32 v[52:53], v[184:185], v[52:53]
    v_pk_add_f32 v[54:55], v[188:189], v[54:55]
    v_pk_add_f32 v[48:49], v[178:179], v[48:49]
    v_pk_add_f32 v[50:51], v[182:183], v[50:51]
    v_pk_add_f32 v[52:53], v[186:187], v[52:53]
    v_pk_add_f32 v[54:55], v[190:191], v[54:55]
    s_waitcnt vmcnt(0)
    v_lshlrev_b32 v192, 16, v152
    v_and_b32 v193, 0xffff0000, v152
    v_lshlrev_b32 v194, 16, v168
    v_and_b32 v195, 0xffff0000, v168
    v_lshlrev_b32 v196, 16, v153
    v_and_b32 v197, 0xffff0000, v153
    v_lshlrev_b32 v198, 16, v169
    v_and_b32 v199, 0xffff0000, v169
    v_lshlrev_b32 v200, 16, v154
    v_and_b32 v201, 0xffff0000, v154
    v_lshlrev_b32 v202, 16, v170
    v_and_b32 v203, 0xffff0000, v170
    v_lshlrev_b32 v204, 16, v155
    v_and_b32 v205, 0xffff0000, v155
    v_lshlrev_b32 v206, 16, v171
    v_and_b32 v207, 0xffff0000, v171
    v_pk_add_f32 v[56:57], v[192:193], v[56:57]
    v_pk_add_f32 v[58:59], v[196:197], v[58:59]
    v_pk_add_f32 v[60:61], v[200:201], v[60:61]
    v_pk_add_f32 v[62:63], v[204:205], v[62:63]
    v_pk_add_f32 v[56:57], v[194:195], v[56:57]
    v_pk_add_f32 v[58:59], v[198:199], v[58:59]
    v_pk_add_f32 v[60:61], v[202:203], v[60:61]
    v_pk_add_f32 v[62:63], v[206:207], v[62:63]
    v_pk_add_f32 v[28:29], v[32:33], v[34:35]
    v_pk_mul_f32 v[30:31], v[32:33], v[32:33]
    v_pk_add_f32 v[16:17], v[48:49], v[50:51]
    v_pk_mul_f32 v[18:19], v[48:49], v[48:49]
    v_pk_fma_f32 v[30:31], v[34:35], v[34:35], v[30:31]
    v_pk_fma_f32 v[18:19], v[50:51], v[50:51], v[18:19]
    v_pk_add_f32 v[28:29], v[28:29], v[36:37]
    v_pk_fma_f32 v[30:31], v[36:37], v[36:37], v[30:31]
    v_pk_add_f32 v[16:17], v[16:17], v[52:53]
    v_pk_fma_f32 v[18:19], v[52:53], v[52:53], v[18:19]
    v_pk_add_f32 v[28:29], v[28:29], v[38:39]
    v_pk_fma_f32 v[30:31], v[38:39], v[38:39], v[30:31]
    v_pk_add_f32 v[16:17], v[16:17], v[54:55]
    v_pk_fma_f32 v[18:19], v[54:55], v[54:55], v[18:19]
    v_pk_add_f32 v[28:29], v[28:29], v[40:41]
    v_pk_fma_f32 v[30:31], v[40:41], v[40:41], v[30:31]
    v_pk_add_f32 v[16:17], v[16:17], v[56:57]
    v_pk_fma_f32 v[18:19], v[56:57], v[56:57], v[18:19]
    v_pk_add_f32 v[28:29], v[28:29], v[42:43]
    v_pk_fma_f32 v[30:31], v[42:43], v[42:43], v[30:31]
    v_pk_add_f32 v[16:17], v[16:17], v[58:59]
    v_pk_fma_f32 v[18:19], v[58:59], v[58:59], v[18:19]
    v_pk_add_f32 v[28:29], v[28:29], v[44:45]
    v_pk_fma_f32 v[30:31], v[44:45], v[44:45], v[30:31]
    v_pk_add_f32 v[16:17], v[16:17], v[60:61]
    v_pk_fma_f32 v[18:19], v[60:61], v[60:61], v[18:19]
    v_pk_add_f32 v[28:29], v[28:29], v[46:47]
    v_pk_fma_f32 v[30:31], v[46:47], v[46:47], v[30:31]
    v_pk_add_f32 v[16:17], v[16:17], v[62:63]
    v_pk_fma_f32 v[18:19], v[62:63], v[62:63], v[18:19]
    v_pk_add_f32 v[28:29], v[28:29], v[16:17]
    v_pk_add_f32 v[30:31], v[30:31], v[18:19]
    v_add_f32 v28, v28, v29
    v_add_f32 v29, v30, v31
    s_nop 1
    v_permlane32_swap_b32 v28, v29
    s_nop 1
    v_add_f32 v28, v28, v29
    v_mov_b32 v29, v28
    s_nop 1
    v_permlane16_swap_b32 v28, v29
    s_nop 1
    v_add_f32 v28, v28, v29
    s_nop 1
    v_add_f32_dpp v28, v28, v28 row_ror:8 row_mask:0xf bank_mask:0xf
    ds_write_b32 v25, v28 offset:0
    s_waitcnt lgkmcnt(0)
    s_barrier
    ds_read_b128 v[132:135], v24 offset:0
    ds_read_b128 v[136:139], v24 offset:16
    s_mov_b32 s54, 0x3a800000
    s_mov_b32 s55, 0x3727c5ac
    s_waitcnt lgkmcnt(0)
    v_add_f32 v132, v132, v133
    v_add_f32 v134, v134, v135
    v_add_f32 v136, v136, v137
    v_add_f32 v138, v138, v139
    v_add_f32 v132, v132, v134
    v_add_f32 v136, v136, v138
    v_mul_f32 v132, s54, v132
    v_mul_f32 v136, s54, v136
    v_fma_f32 v136, -v132, v132, v136
    v_max_f32 v136, 0, v136
    v_add_f32 v136, s55, v136
    v_rsq_f32 v136, v136
    s_nop 0
    v_mul_f32 v132, -v132, v136
    v_mov_b32 v137, v136
    v_mov_b32 v133, v132
    v_pk_fma_f32 v[176:177], v[32:33], v[136:137], v[132:133]
    v_pk_fma_f32 v[178:179], v[34:35], v[136:137], v[132:133]
    v_pk_fma_f32 v[180:181], v[36:37], v[136:137], v[132:133]
    v_pk_fma_f32 v[182:183], v[38:39], v[136:137], v[132:133]
    v_pk_fma_f32 v[184:185], v[40:41], v[136:137], v[132:133]
    v_pk_fma_f32 v[186:187], v[42:43], v[136:137], v[132:133]
    v_pk_fma_f32 v[188:189], v[44:45], v[136:137], v[132:133]
    v_pk_fma_f32 v[190:191], v[46:47], v[136:137], v[132:133]
    v_pk_fma_f32 v[192:193], v[48:49], v[136:137], v[132:133]
    v_pk_fma_f32 v[194:195], v[50:51], v[136:137], v[132:133]
    v_pk_fma_f32 v[196:197], v[52:53], v[136:137], v[132:133]
    v_pk_fma_f32 v[198:199], v[54:55], v[136:137], v[132:133]
    v_pk_fma_f32 v[200:201], v[56:57], v[136:137], v[132:133]
    v_pk_fma_f32 v[202:203], v[58:59], v[136:137], v[132:133]
    v_pk_fma_f32 v[204:205], v[60:61], v[136:137], v[132:133]
    v_pk_fma_f32 v[206:207], v[62:63], v[136:137], v[132:133]
    s_branch L_lnc
L_fin:
L_end:
    s_endpgm
.section .rodata,"a"
.p2align 6
.amdhsa_kernel interleave_layers__ssm_conv_h3__dense_activation_squared_relu__prompt_kernel
  .amdhsa_next_free_vgpr 512
  .amdhsa_next_free_sgpr 96
  .amdhsa_accum_offset 256
  .amdhsa_group_segment_fixed_size 0
  .amdhsa_kernarg_size 112
  .amdhsa_user_sgpr_count 2
  .amdhsa_user_sgpr_kernarg_segment_ptr 1
  .amdhsa_system_sgpr_workgroup_id_x 1
.end_amdhsa_kernel
```
